```python
import torch

def _softmax(x, axis=-1):
    return torch.softmax(x, dim=axis)
def _gelu(x):
    return torch.nn.functional.gelu(x, approximate="tanh")
def _silu(x):
    return torch.nn.functional.silu(x)
def _sigmoid(x):
    return torch.sigmoid(x)
def _layernorm(x, axis=-1, eps=1e-5):
    m = x.mean(dim=axis, keepdim=True)
    v = x.var(dim=axis, keepdim=True, unbiased=False)
    return (x - m) / torch.sqrt(v + eps)
def _scatter_add(tgt, idx, src, axis=0):
    return tgt.clone().index_add_(axis, idx, src)
def _segment_sum(src, seg, n):
    out = torch.zeros((n,) + src.shape[1:], dtype=src.dtype)
    return out.index_add_(0, seg, src)
def _pad(x, pw):
    flat = tuple(v for pair in reversed(pw) for v in pair)
    return torch.nn.functional.pad(x, flat)

kernel_name = 'parallel_sum__compressed_kv_cla__dense_activation_squared_relu__decode'

def setup_inputs():

    _w = (lambda a: (lambda t: t.to(torch.bfloat16) if t.is_floating_point() else t)(torch.as_tensor(a)))
    def _A_setup():
        B, H, Sq, Sk, D, M = 2, 32, 1, 4096, 128, 576
        Dc = 4 * D
        return {
            "x": _w((lambda *s: torch.randn(*s, dtype=torch.bfloat16) * 0.05)(B, Sq, M)),
            "c_kv": _w((lambda *s: torch.randn(*s, dtype=torch.bfloat16) * 3.2)(B, Sk, Dc)),
            "w_q": _w((lambda *s: torch.randn(*s, dtype=torch.bfloat16) * 1.6)(M, H, D) * (M ** -0.5)),
            "w_uk": _w((lambda *s: torch.randn(*s, dtype=torch.bfloat16) * 1.6)(Dc, H, D) * (Dc ** -0.5)),
            "w_uv": _w((lambda *s: torch.randn(*s, dtype=torch.bfloat16) * 3.2)(Dc, H, D) * (Dc ** -0.5)),
            "w_o": _w((lambda *s: torch.randn(*s, dtype=torch.bfloat16) * 3.2)(H, D, M) * ((H * D) ** -0.5)),
        }
    _A_in = _A_setup()

    def _B_setup():
        B, S, D, F = 2, 1, 576, 4608
        return {
            "x": _w((lambda *s: torch.randn(*s, dtype=torch.bfloat16) * 0.05)(B, S, D)),
            "w1": _w((lambda *s: torch.randn(*s, dtype=torch.bfloat16) * 0.1)(D, F)),
            "b1": _w((lambda *s: torch.randn(*s, dtype=torch.bfloat16) * 0.4)(F)),
            "w2": _w((lambda *s: torch.randn(*s, dtype=torch.bfloat16) * 0.1)(F, D)),
            "b2": _w((lambda *s: torch.randn(*s, dtype=torch.bfloat16) * 12.8)(D)),
        }
    _B_in = _B_setup()

    return {
        "A_x": _A_in["x"],
        "A_c_kv": _A_in["c_kv"],
        "A_w_q": _A_in["w_q"],
        "A_w_uk": _A_in["w_uk"],
        "A_w_uv": _A_in["w_uv"],
        "A_w_o": _A_in["w_o"],
        "B_x": _B_in["x"],
        "B_w1": _B_in["w1"],
        "B_b1": _B_in["b1"],
        "B_w2": _B_in["w2"],
        "B_b2": _B_in["b2"],
    }

def reference(A_x, A_c_kv, A_w_q, A_w_uk, A_w_uv, A_w_o, B_x, B_w1, B_b1, B_w2, B_b2):
    def _A_ref(x, c_kv, w_q, w_uk, w_uv, w_o):
        B, Sq, M = x.shape[0], x.shape[1], x.shape[2]
        Sk = c_kv.shape[1]
        H, D = w_q.shape[1], w_q.shape[2]
        q = torch.einsum("bqm,mhd->bhqd", x, w_q)
        k = torch.einsum("bkc,chd->bhkd", c_kv, w_uk)
        v = torch.einsum("bkc,chd->bhkd", c_kv, w_uv)
        scores = torch.einsum("bhqd,bhkd->bhqk", q, k) * (D ** -0.5)
        off = Sk - Sq
        qi = torch.arange(Sq)[:, None]
        kj = torch.arange(Sk)[None, :]
        cmask = kj <= (qi + off)
        scores = torch.where(cmask[None, None], scores, -1e9)
        p = _softmax(scores, axis=-1)
        ctx = torch.einsum("bhqk,bhkd->bhqd", p, v)
        return torch.einsum("bhqd,hdm->bqm", ctx, w_o)

    def _B_ref(x, w1, b1, w2, b2):
        h = torch.einsum("bsd,df->bsf", x, w1) + b1
        zero = torch.zeros_like(h)
        r = torch.where(h > zero, h, zero)
        h = r * r
        out = torch.einsum("bsf,fd->bsd", h, w2) + b2
        return out

    x = A_x
    xn = _layernorm(x, axis=-1)
    return x + _A_ref(xn, A_c_kv, A_w_q, A_w_uk, A_w_uv, A_w_o) + _B_ref(xn, B_w1, B_b1, B_w2, B_b2)
```

```asm
; @launch grid=(256,1,1) block=(512,1,1) lds=158272
.amdgcn_target "amdgcn-amd-amdhsa--gfx950"
.text
.globl parallel_sum__compressed_kv_cla__dense_activation_squared_relu__decode_kernel
.p2align 8
.type parallel_sum__compressed_kv_cla__dense_activation_squared_relu__decode_kernel,@function
parallel_sum__compressed_kv_cla__dense_activation_squared_relu__decode_kernel:
L_code0:
    s_load_dwordx2 s[4:5], s[0:1], 0
    s_load_dwordx2 s[8:9], s[0:1], 8
    s_load_dwordx2 s[12:13], s[0:1], 16
    s_load_dwordx2 s[16:17], s[0:1], 24
    s_load_dwordx2 s[20:21], s[0:1], 104
    v_readfirstlane_b32 s3, v0
    s_cmp_ge_u32 s2, 256
    s_cbranch_scc1 L_end
    v_and_b32 v1, 63, v0
    s_and_b32 s58, s2, 7
    s_lshr_b32 s59, s2, 4
    s_lshr_b32 s3, s3, 6
    s_cmp_ge_u32 s3, 4
    s_cbranch_scc1 L_hi
    s_bitcmp1_b32 s2, 3
    s_cbranch_scc1 L_SC
    s_cmp_lg_u32 s3, 0
    s_cbranch_scc1 L_Q123
    s_setprio 3
    s_mov_b32 s6, 2304
    s_mov_b32 s7, 0x20000
    v_lshrrev_b32 v10, 5, v1
    v_mul_u32_u24 v10, 1152, v10
    v_and_b32 v11, 31, v1
    v_lshl_add_u32 v30, v11, 4, v10
    v_lshl_add_u32 v31, v11, 2, v10
    s_waitcnt lgkmcnt(0)
    buffer_load_dwordx4 v[12:15], v30, s[4:7], 0 offen
    buffer_load_dwordx4 v[16:19], v30, s[4:7], 0 offen offset:512
    buffer_load_dword v20, v31, s[4:7], 0 offen offset:1024
    v_mov_b32 v34, 41344
    v_mov_b32 v11, 0
    ds_write_b32 v34, v11
    s_waitcnt lgkmcnt(0)
    s_barrier
    s_branch L_Q0
L_hi:
    s_getpc_b64 s[72:73]
L_pc:
    s_lshr_b32 s66, s2, 3
    s_mul_i32 s66, s66, 768
    s_mul_i32 s69, s3, 192
    s_add_u32 s66, s66, s69
    s_add_u32 s66, s66, -768
    s_min_u32 s66, s66, L_code1-L_pc-192
    s_add_u32 s72, s72, s66
    s_addc_u32 s73, s73, 0
    s_load_dword s74, s[72:73], 0
    s_load_dword s74, s[72:73], 64
    s_load_dword s74, s[72:73], 128
    s_bitcmp1_b32 s2, 3
    s_cbranch_scc1 L_PV
    s_barrier
    s_branch L_Q47
L_Q3:
    s_mov_b32 s18, 4194304
    s_mov_b32 s19, 0x20000
    s_mov_b32 s22, 268435456
    s_mov_b32 s23, 0x20000
    s_and_b32 s66, s59, 3
    s_lshr_b32 s55, s59, 2
    s_lshl_b32 s54, s58, 2
    s_add_u32 s54, s54, s66
    v_lshlrev_b32 v10, 13, v3
    v_lshl_add_u32 v12, v2, 4, v10
    v_lshlrev_b32 v24, 5, v1
    s_lshl_b32 s77, s55, 20
    s_lshl_b32 s69, s54, 8
    s_add_u32 s77, s77, s69
    s_lshl_b32 s66, s54, 13
    s_lshl_b32 s69, s55, 11
    s_add_u32 s66, s66, s69
    s_add_u32 s66, s66, 65536
    s_mov_b32 m0, 0
    s_waitcnt lgkmcnt(0)
    s_barrier
    buffer_load_dword v24, v24, s[20:23], s66 offen sc1
L_ukl:
    buffer_load_dwordx4 v12, s[16:19], s77 offen nt lds
    s_add_u32 m0, m0, 1056
    s_add_u32 s77, s77, 32768
    s_cmp_lt_u32 m0, 21120
    s_cbranch_scc1 L_ukl
    s_branch L_Q3b
L_SC:
    s_mov_b32 s10, 8388608
    s_mov_b32 s11, 0x20000
    s_lshr_b32 s66, s59, 1
    s_lshl_b32 s57, s58, 3
    s_add_u32 s57, s57, s66
    s_lshl_b32 s71, s57, 17
    s_mul_i32 s69, s3, 33792
    s_add_u32 s71, s71, s69
    s_lshl_b32 s69, s66, 12
    s_add_u32 s71, s71, s69
    s_mul_i32 m0, s3, 33792
    v_lshlrev_b32 v8, 4, v1
    s_waitcnt lgkmcnt(0)
    buffer_load_dwordx4 v8, s[8:11], s71 offen nt lds
    s_add_u32 m0, m0, 1056
    s_xor_b32 s71, s71, 4096
    buffer_load_dwordx4 v8, s[8:11], s71 offen nt lds
    s_add_u32 m0, m0, 1056
    s_xor_b32 s71, s71, 12288
    buffer_load_dwordx4 v8, s[8:11], s71 offen nt lds
    s_add_u32 m0, m0, 1056
    s_xor_b32 s71, s71, 4096
    buffer_load_dwordx4 v8, s[8:11], s71 offen nt lds
    s_add_u32 m0, m0, 1056
    s_xor_b32 s71, s71, 28672
    buffer_load_dwordx4 v8, s[8:11], s71 offen nt lds
    s_add_u32 m0, m0, 1056
    s_xor_b32 s71, s71, 4096
    buffer_load_dwordx4 v8, s[8:11], s71 offen nt lds
    s_add_u32 m0, m0, 1056
    s_xor_b32 s71, s71, 12288
    buffer_load_dwordx4 v8, s[8:11], s71 offen nt lds
    s_add_u32 m0, m0, 1056
    s_xor_b32 s71, s71, 4096
    buffer_load_dwordx4 v8, s[8:11], s71 offen nt lds
    s_add_u32 m0, m0, 1056
    s_xor_b32 s71, s71, 29696
    s_branch L_SC2
L_Q123:
    v_and_b32 v2, 15, v1
    v_lshrrev_b32 v3, 4, v1
    s_cmp_eq_u32 s3, 3
    s_cbranch_scc1 L_Q3
    s_mov_b32 s14, 4718592
    s_mov_b32 s15, 0x20000
    s_and_b32 s66, s59, 3
    s_lshr_b32 s55, s59, 2
    s_lshl_b32 s67, s66, 3
    s_lshl_b32 s69, s3, 2
    s_add_u32 s67, s67, s69
    s_add_u32 s67, s67, -4
    s_lshr_b32 s67, 0x73562410, s67
    s_and_b32 s66, s67, 3
    s_bfe_u32 s67, s67, 0x10002
    s_lshl_b32 s75, s58, 2
    s_add_u32 s75, s75, s66
    s_lshl_b32 s72, s55, 1
    s_add_u32 s72, s72, s67
    v_mul_u32_u24 v10, 8192, v3
    v_lshl_add_u32 v12, v2, 4, v10
    s_mul_i32 s73, s72, 589824
    s_lshl_b32 s69, s75, 8
    s_add_u32 s73, s73, s69
    s_waitcnt lgkmcnt(0)
    buffer_load_dwordx4 v[96:99], v12, s[12:15], s73 offen nt
    s_add_u32 s73, s73, 32768
    buffer_load_dwordx4 v[100:103], v12, s[12:15], s73 offen nt
    s_add_u32 s73, s73, 32768
    buffer_load_dwordx4 v[104:107], v12, s[12:15], s73 offen nt
    s_add_u32 s73, s73, 32768
    buffer_load_dwordx4 v[108:111], v12, s[12:15], s73 offen nt
    s_add_u32 s73, s73, 32768
    buffer_load_dwordx4 v[112:115], v12, s[12:15], s73 offen nt
    s_add_u32 s73, s73, 32768
    buffer_load_dwordx4 v[116:119], v12, s[12:15], s73 offen nt
    s_add_u32 s73, s73, 32768
    buffer_load_dwordx4 v[120:123], v12, s[12:15], s73 offen nt
    s_add_u32 s73, s73, 32768
    buffer_load_dwordx4 v[124:127], v12, s[12:15], s73 offen nt
    s_add_u32 s73, s73, 32768
    buffer_load_dwordx4 v[128:131], v12, s[12:15], s73 offen nt
    s_add_u32 s73, s73, 32768
    buffer_load_dwordx4 v[132:135], v12, s[12:15], s73 offen nt
    s_add_u32 s73, s73, 32768
    buffer_load_dwordx4 v[136:139], v12, s[12:15], s73 offen nt
    s_add_u32 s73, s73, 32768
    buffer_load_dwordx4 v[140:143], v12, s[12:15], s73 offen nt
    s_add_u32 s73, s73, 32768
    buffer_load_dwordx4 v[144:147], v12, s[12:15], s73 offen nt
    s_add_u32 s73, s73, 32768
    buffer_load_dwordx4 v[148:151], v12, s[12:15], s73 offen nt
    s_add_u32 s73, s73, 32768
    buffer_load_dwordx4 v[152:155], v12, s[12:15], s73 offen nt
    s_add_u32 s73, s73, 32768
    buffer_load_dwordx4 v[156:159], v12, s[12:15], s73 offen nt
    s_add_u32 s73, s73, 32768
    s_barrier
    buffer_load_dwordx4 v[160:163], v12, s[12:15], s73 offen nt
    s_add_u32 s73, s73, 32768
    buffer_load_dwordx4 v[164:167], v12, s[12:15], s73 offen nt
    s_load_dword s53, s[20:21], 0
    s_load_dwordx2 s[28:29], s[0:1], 40
    s_load_dwordx2 s[40:41], s[0:1], 72
    s_load_dwordx2 s[44:45], s[0:1], 80
    s_load_dwordx2 s[48:49], s[0:1], 88
    s_mov_b32 s22, 268435456
    s_mov_b32 s23, 0x20000
    s_mov_b32 s30, 4718592
    s_mov_b32 s31, 0x20000
    s_mov_b32 s42, 5308416
    s_mov_b32 s43, 0x20000
    s_mov_b32 s6, 2304
    s_mov_b32 s7, 0x20000
    s_mov_b32 s46, 1152
    s_mov_b32 s47, 0x20000
    s_mov_b32 s50, 2304
    s_mov_b32 s51, 0x20000
    s_lshl_b32 s65, s59, 3
    s_add_u32 s65, s65, s58
    s_and_b32 s52, s3, 3
    s_and_b32 s69, s59, 3
    s_lshl_b32 s54, s58, 2
    s_add_u32 s54, s54, s69
    s_lshr_b32 s55, s59, 2
    v_lshlrev_b32 v8, 4, v1
    v_bfe_u32 v9, v1, 2, 1
    v_and_b32 v10, 3, v1
    v_lshlrev_b32 v10, 4, v10
    v_mov_b32 v4, 0xffff
    v_mov_b32 v5, 0
    v_lshlrev_b64 v[4:5], v10, v[4:5]
    v_bfe_i32 v10, v1, 3, 1
    v_and_b32 v6, v10, v4
    v_and_b32 v7, v10, v5
    v_xor_b32 v4, v4, v6
    v_xor_b32 v5, v5, v7
    s_mov_b32 s60, 0x07060501
    s_mov_b32 s61, 0x07060502
    s_mov_b32 s62, 0x07060503
    s_mov_b32 s63, 0x04000c0c
    s_mov_b32 s64, 0x0706000c
    s_mov_b32 s100, 0x01000100
    s_mov_b32 s101, 0x03020302
    s_setprio 3
    s_lshl_b32 s71, s55, 1
    s_add_u32 s71, s71, s3
    s_add_u32 s71, s71, -1
    s_mul_i32 s67, s72, 144
    s_add_u32 s67, s67, 34432
    v_mul_u32_u24 v10, 2, v3
    v_mul_u32_u24 v11, 1152, v9
    v_add3_u32 v31, v10, v11, s67
    s_lshl_b32 s77, s75, 13
    s_lshl_b32 s69, s72, 10
    s_add_u32 s77, s77, s69
    s_add_u32 s77, s77, 65536
    v_mov_b32 v13, 41344
    s_waitcnt lgkmcnt(0)
    s_add_u32 s53, s53, 1
    v_mov_b32 v83, s53
L_xw:
    ds_read_b32 v14, v13
    s_waitcnt lgkmcnt(0)
    v_cmp_eq_u32 vcc, 0, v14
    s_cbranch_vccnz L_xw
    ds_read_u16 v36, v31 offset:0
    ds_read_u16 v37, v31 offset:8
    ds_read_u16 v38, v31 offset:16
    ds_read_u16 v39, v31 offset:24
    ds_read_u16 v40, v31 offset:32
    ds_read_u16 v41, v31 offset:40
    ds_read_u16 v42, v31 offset:48
    ds_read_u16 v43, v31 offset:56
    ds_read_u16 v44, v31 offset:64
    ds_read_u16 v45, v31 offset:72
    ds_read_u16 v46, v31 offset:80
    ds_read_u16 v47, v31 offset:88
    ds_read_u16 v48, v31 offset:96
    ds_read_u16 v49, v31 offset:104
    ds_read_u16 v50, v31 offset:112
    ds_read_u16 v51, v31 offset:120
    ds_read_u16 v52, v31 offset:128
    ds_read_u16 v53, v31 offset:136
    s_waitcnt lgkmcnt(12)
    v_perm_b32 v66, v36, v36, s100
    v_and_b32 v68, v66, v4
    v_and_b32 v69, v66, v5
    v_and_b32 v70, v66, v6
    v_and_b32 v71, v66, v7
    v_perm_b32 v66, v37, v37, s100
    v_and_b32 v72, v66, v4
    v_and_b32 v73, v66, v5
    v_and_b32 v74, v66, v6
    v_and_b32 v75, v66, v7
    s_waitcnt vmcnt(17)
    v_mfma_f32_16x16x32_bf16 v[76:79], v[68:71], v[96:99], 0
    v_perm_b32 v66, v38, v38, s100
    v_and_b32 v68, v66, v4
    v_and_b32 v69, v66, v5
    v_and_b32 v70, v66, v6
    v_and_b32 v71, v66, v7
    s_waitcnt vmcnt(16)
    v_mfma_f32_16x16x32_bf16 v[76:79], v[72:75], v[100:103], v[76:79]
    v_perm_b32 v66, v39, v39, s100
    v_and_b32 v72, v66, v4
    v_and_b32 v73, v66, v5
    v_and_b32 v74, v66, v6
    v_and_b32 v75, v66, v7
    s_waitcnt vmcnt(15)
    v_mfma_f32_16x16x32_bf16 v[76:79], v[68:71], v[104:107], v[76:79]
    v_perm_b32 v66, v40, v40, s100
    v_and_b32 v68, v66, v4
    v_and_b32 v69, v66, v5
    v_and_b32 v70, v66, v6
    v_and_b32 v71, v66, v7
    s_waitcnt vmcnt(14)
    v_mfma_f32_16x16x32_bf16 v[76:79], v[72:75], v[108:111], v[76:79]
    v_perm_b32 v66, v41, v41, s100
    v_and_b32 v72, v66, v4
    v_and_b32 v73, v66, v5
    v_and_b32 v74, v66, v6
    v_and_b32 v75, v66, v7
    s_waitcnt vmcnt(13)
    v_mfma_f32_16x16x32_bf16 v[76:79], v[68:71], v[112:115], v[76:79]
    s_waitcnt lgkmcnt(0)
    v_perm_b32 v66, v42, v42, s100
    v_and_b32 v68, v66, v4
    v_and_b32 v69, v66, v5
    v_and_b32 v70, v66, v6
    v_and_b32 v71, v66, v7
    s_waitcnt vmcnt(12)
    v_mfma_f32_16x16x32_bf16 v[76:79], v[72:75], v[116:119], v[76:79]
    v_perm_b32 v66, v43, v43, s100
    v_and_b32 v72, v66, v4
    v_and_b32 v73, v66, v5
    v_and_b32 v74, v66, v6
    v_and_b32 v75, v66, v7
    s_waitcnt vmcnt(11)
    v_mfma_f32_16x16x32_bf16 v[76:79], v[68:71], v[120:123], v[76:79]
    v_perm_b32 v66, v44, v44, s100
    v_and_b32 v68, v66, v4
    v_and_b32 v69, v66, v5
    v_and_b32 v70, v66, v6
    v_and_b32 v71, v66, v7
    s_waitcnt vmcnt(10)
    v_mfma_f32_16x16x32_bf16 v[76:79], v[72:75], v[124:127], v[76:79]
    v_perm_b32 v66, v45, v45, s100
    v_and_b32 v72, v66, v4
    v_and_b32 v73, v66, v5
    v_and_b32 v74, v66, v6
    v_and_b32 v75, v66, v7
    s_waitcnt vmcnt(9)
    v_mfma_f32_16x16x32_bf16 v[76:79], v[68:71], v[128:131], v[76:79]
    v_perm_b32 v66, v46, v46, s100
    v_and_b32 v68, v66, v4
    v_and_b32 v69, v66, v5
    v_and_b32 v70, v66, v6
    v_and_b32 v71, v66, v7
    s_waitcnt vmcnt(8)
    v_mfma_f32_16x16x32_bf16 v[76:79], v[72:75], v[132:135], v[76:79]
    v_perm_b32 v66, v47, v47, s100
    v_and_b32 v72, v66, v4
    v_and_b32 v73, v66, v5
    v_and_b32 v74, v66, v6
    v_and_b32 v75, v66, v7
    s_waitcnt vmcnt(7)
    v_mfma_f32_16x16x32_bf16 v[76:79], v[68:71], v[136:139], v[76:79]
    v_perm_b32 v66, v48, v48, s100
    v_and_b32 v68, v66, v4
    v_and_b32 v69, v66, v5
    v_and_b32 v70, v66, v6
    v_and_b32 v71, v66, v7
    s_waitcnt vmcnt(6)
    v_mfma_f32_16x16x32_bf16 v[76:79], v[72:75], v[140:143], v[76:79]
    v_perm_b32 v66, v49, v49, s100
    v_and_b32 v72, v66, v4
    v_and_b32 v73, v66, v5
    v_and_b32 v74, v66, v6
    v_and_b32 v75, v66, v7
    s_waitcnt vmcnt(5)
    v_mfma_f32_16x16x32_bf16 v[76:79], v[68:71], v[144:147], v[76:79]
    v_perm_b32 v66, v50, v50, s100
    v_and_b32 v68, v66, v4
    v_and_b32 v69, v66, v5
    v_and_b32 v70, v66, v6
    v_and_b32 v71, v66, v7
    s_waitcnt vmcnt(4)
    v_mfma_f32_16x16x32_bf16 v[76:79], v[72:75], v[148:151], v[76:79]
    v_perm_b32 v66, v51, v51, s100
    v_and_b32 v72, v66, v4
    v_and_b32 v73, v66, v5
    v_and_b32 v74, v66, v6
    v_and_b32 v75, v66, v7
    s_waitcnt vmcnt(3)
    v_mfma_f32_16x16x32_bf16 v[76:79], v[68:71], v[152:155], v[76:79]
    v_perm_b32 v66, v52, v52, s100
    v_and_b32 v68, v66, v4
    v_and_b32 v69, v66, v5
    v_and_b32 v70, v66, v6
    v_and_b32 v71, v66, v7
    s_waitcnt vmcnt(2)
    v_mfma_f32_16x16x32_bf16 v[76:79], v[72:75], v[156:159], v[76:79]
    v_perm_b32 v66, v53, v53, s100
    v_and_b32 v72, v66, v4
    v_and_b32 v73, v66, v5
    v_and_b32 v74, v66, v6
    v_and_b32 v75, v66, v7
    s_waitcnt vmcnt(1)
    v_mfma_f32_16x16x32_bf16 v[76:79], v[68:71], v[160:163], v[76:79]
    s_waitcnt vmcnt(0)
    v_mfma_f32_16x16x32_bf16 v[76:79], v[72:75], v[164:167], v[76:79]
    s_mul_i32 s67, s3, 16896
    s_add_u32 s67, s67, -16896
    v_mul_u32_u24 v84, 1056, v2
    v_lshl_add_u32 v84, v3, 4, v84
    v_add_u32 v84, s67, v84
    v_mul_u32_u24 v86, 288, v9
    v_lshl_add_u32 v86, v3, 4, v86
    v_add_u32 v86, 33792, v86
    v_perm_b32 v80, v76, v79, s60
    v_perm_b32 v81, v77, v79, s61
    v_perm_b32 v82, v78, v79, s62
    buffer_store_dwordx4 v[80:83], v8, s[20:23], s77 offen
    s_barrier
    s_lshl_b32 s67, s3, 10
    s_add_u32 s67, s67, 35712
    v_add_u32 v10, s67, v8
    ds_write_b128 v10, v[80:83]
    s_lshl_b32 s67, s3, 8
    s_add_u32 s67, s67, 38528
    v_lshl_add_u32 v10, v1, 2, s67
    v_add_u32 v11, s77, v8
    ds_write_b32 v10, v11
    v_lshlrev_b32 v87, 15, v3
    v_lshl_add_u32 v87, v2, 3, v87
    s_lshl_b32 s76, s54, 10
    s_lshl_b32 s69, s71, 7
    s_add_u32 s76, s76, s69
    s_add_u32 s76, s76, 327680
    v_and_b32 v11, 7, v1
    v_lshlrev_b32 v11, 2, v11
    s_mul_i32 s66, s53, 0x01010101
    s_xor_b32 s66, s66, 0x6b2d91c4
    v_lshrrev_b32 v11, v11, s66
    v_bfe_u32 v88, v11, 0, 1
    v_bfe_u32 v10, v11, 1, 1
    v_lshl_or_b32 v88, v10, 16, v88
    v_bfe_u32 v89, v11, 2, 1
    v_bfe_u32 v10, v11, 3, 1
    v_lshl_or_b32 v89, v10, 16, v89
    s_mov_b32 s73, 0x07060302
    s_mov_b32 s74, 0xfffefffe
    s_lshl_b32 s75, s58, 10
    s_lshl_b32 s69, s59, 6
    s_add_u32 s75, s75, s69
    s_add_u32 s75, s75, 999424
    v_mov_b32 v92, 41408
    v_mov_b32 v11, 0
    ds_write_b32 v92, v11
    s_waitcnt lgkmcnt(0)
    s_barrier
    s_barrier
    s_barrier
    s_barrier
    ds_read_b128 v[96:99], v84 offset:0
    ds_read_b128 v[112:115], v84 offset:256
    ds_read_b128 v[128:131], v84 offset:512
    ds_read_b128 v[144:147], v84 offset:768
    ds_read_b128 v[100:103], v84 offset:64
    ds_read_b128 v[116:119], v84 offset:320
    ds_read_b128 v[132:135], v84 offset:576
    ds_read_b128 v[148:151], v84 offset:832
    ds_read_b128 v[104:107], v84 offset:128
    ds_read_b128 v[120:123], v84 offset:384
    ds_read_b128 v[136:139], v84 offset:640
    ds_read_b128 v[152:155], v84 offset:896
    ds_read_b128 v[108:111], v84 offset:192
    ds_read_b128 v[124:127], v84 offset:448
    ds_read_b128 v[140:143], v84 offset:704
    ds_read_b128 v[156:159], v84 offset:960
    s_barrier
    ds_read_b128 v[16:19], v86 offset:0
    ds_read_b128 v[20:23], v86 offset:64
    ds_read_b128 v[24:27], v86 offset:128
    ds_read_b128 v[28:31], v86 offset:192
    s_waitcnt lgkmcnt(3)
    v_mfma_f32_16x16x32_bf16 v[32:35], v[16:19], v[96:99], 0
    v_mfma_f32_16x16x32_bf16 v[36:39], v[16:19], v[112:115], 0
    v_mfma_f32_16x16x32_bf16 v[40:43], v[16:19], v[128:131], 0
    v_mfma_f32_16x16x32_bf16 v[44:47], v[16:19], v[144:147], 0
    s_waitcnt lgkmcnt(2)
    v_mfma_f32_16x16x32_bf16 v[32:35], v[20:23], v[100:103], v[32:35]
    v_mfma_f32_16x16x32_bf16 v[36:39], v[20:23], v[116:119], v[36:39]
    v_mfma_f32_16x16x32_bf16 v[40:43], v[20:23], v[132:135], v[40:43]
    v_mfma_f32_16x16x32_bf16 v[44:47], v[20:23], v[148:151], v[44:47]
    s_waitcnt lgkmcnt(1)
    v_mfma_f32_16x16x32_bf16 v[32:35], v[24:27], v[104:107], v[32:35]
    v_mfma_f32_16x16x32_bf16 v[36:39], v[24:27], v[120:123], v[36:39]
    v_mfma_f32_16x16x32_bf16 v[40:43], v[24:27], v[136:139], v[40:43]
    v_mfma_f32_16x16x32_bf16 v[44:47], v[24:27], v[152:155], v[44:47]
    s_waitcnt lgkmcnt(0)
    v_mfma_f32_16x16x32_bf16 v[32:35], v[28:31], v[108:111], v[32:35]
    v_mfma_f32_16x16x32_bf16 v[36:39], v[28:31], v[124:127], v[36:39]
    v_mfma_f32_16x16x32_bf16 v[40:43], v[28:31], v[140:143], v[40:43]
    v_mfma_f32_16x16x32_bf16 v[44:47], v[28:31], v[156:159], v[44:47]
    s_mov_b64 exec, 0xffffffff
    s_nop 3
    v_add_u32 v32, 0x10000, v32
    v_add_u32 v36, 0x10000, v36
    v_add_u32 v40, 0x10000, v40
    v_add_u32 v44, 0x10000, v44
    v_perm_b32 v12, v36, v32, s73
    v_perm_b32 v13, v44, v40, s73
    v_and_or_b32 v12, v12, s74, v88
    v_and_or_b32 v13, v13, s74, v89
    buffer_store_dwordx2 v[12:13], v87, s[20:23], s76 offen sc1
    s_mov_b64 exec, -1
    s_cmp_eq_u32 s3, 1
    s_cbranch_scc1 L_Q1
    s_mov_b64 exec, 1
    buffer_store_dword v83, v8, s[20:23], s75 offen
    s_mov_b64 exec, -1
    s_setprio 0
    s_barrier
    s_lshl_b32 s67, s58, 10
    s_add_u32 s67, s67, 1015808
    v_lshlrev_b32 v25, 6, v2
    buffer_load_dword v26, v25, s[20:23], s67 offen sc1
    s_sub_u32 s66, s67, 32768
    buffer_load_dword v27, v25, s[20:23], s66 offen sc1
    v_lshlrev_b32 v87, 10, v1
    s_and_b32 s66, s54, 3
    s_lshl_b32 s77, s58, 7
    s_lshl_b32 s69, s66, 4
    s_add_u32 s77, s77, s69
    s_add_u32 s77, s77, 393216
    v_lshlrev_b32 v88, 2, v1
    v_add_u32 v88, 41472, v88
    v_mul_u32_u24 v10, 2112, v3
    v_lshrrev_b32 v11, 2, v2
    v_lshl_add_u32 v10, v11, 8, v10
    v_and_b32 v11, 3, v1
    v_lshl_add_u32 v10, v11, 3, v10
    s_lshl_b32 s66, s3, 5
    v_add_u32 v251, s66, v10
    v_and_b32 v10, 7, v1
    v_mul_u32_u24 v248, 288, v10
    v_lshl_add_u32 v248, v3, 4, v248
    v_add_u32 v248, 41728, v248
    v_lshlrev_b32 v249, 9, v9
    v_lshl_add_u32 v249, v3, 4, v249
    v_mov_b32 v250, 41408
    s_lshl_b32 s65, s54, 13
    s_lshl_b32 s69, s55, 10
    s_add_u32 s65, s65, s69
    s_lshl_b32 s69, s3, 6
    s_add_u32 s65, s65, s69
    s_add_u32 s65, s65, 65536
    s_xor_b32 s66, s53, 0x5a5a0000
    v_mov_b32 v255, s66
    s_barrier
    s_barrier
    s_mov_b32 s70, 200000
    s_getreg_b32 s68, hwreg(HW_REG_XCC_ID)
    s_setprio 3
    s_mov_b32 s66, 40
L_g3:
    buffer_load_dwordx2 v[26:27], v25, s[20:23], s67 offen sc1
    s_sub_u32 s66, s66, 1
    s_cbranch_scc1 L_g3_r
    s_waitcnt vmcnt(0)
    v_cmp_ne_u32 vcc, s53, v26
    s_cbranch_vccnz L_g3
L_g3_k:
    buffer_load_dwordx4 v[32:35], v87, s[20:23], s77 offen sc1
    v_xor_b32 v26, s53, v26
    v_bitop3_b32 v26, v27, s68, v26 bitop3:0xbe
    v_cmp_ne_u32 vcc, 0, v26
    s_cmp_eq_u64 vcc, 0
    s_cselect_b32 s68, 1, 2
    v_mov_b32 v11, s68
    ds_write_b32 v92, v11
L_stw:
    s_waitcnt vmcnt(0)
    v_cmp_ne_u32 vcc, s53, v35
    s_cbranch_vccnz L_str
L_stok:
    s_barrier
    s_mov_b64 exec, -1
    v_mov_b32 v36, v32
    s_nop 1
    v_max_f32_dpp v36, v36, v36 quad_perm:[1,0,3,2] row_mask:0xf bank_mask:0xf
    s_nop 1
    v_max_f32_dpp v36, v36, v36 quad_perm:[2,3,0,1] row_mask:0xf bank_mask:0xf
    s_nop 1
    v_max_f32_dpp v36, v36, v36 row_ror:4 row_mask:0xf bank_mask:0xf
    s_nop 1
    v_max_f32_dpp v36, v36, v36 row_ror:8 row_mask:0xf bank_mask:0xf
    v_mov_b32 v37, v36
    s_nop 1
    v_permlane16_swap_b32 v36, v37
    v_max_f32 v36, v36, v37
    v_sub_f32 v32, v32, v36
    v_exp_f32 v32, v32
    s_nop 0
    v_mul_f32 v36, v32, v33
    s_nop 1
    v_add_f32_dpp v36, v36, v36 quad_perm:[1,0,3,2] row_mask:0xf bank_mask:0xf
    s_nop 1
    v_add_f32_dpp v36, v36, v36 quad_perm:[2,3,0,1] row_mask:0xf bank_mask:0xf
    s_nop 1
    v_add_f32_dpp v36, v36, v36 row_ror:4 row_mask:0xf bank_mask:0xf
    s_nop 1
    v_add_f32_dpp v36, v36, v36 row_ror:8 row_mask:0xf bank_mask:0xf
    v_mov_b32 v37, v36
    s_nop 1
    v_permlane16_swap_b32 v36, v37
    v_add_f32 v36, v36, v37
    v_rcp_f32 v36, v36
    s_nop 0
    v_mul_f32 v32, v32, v36
    v_cvt_pk_bf16_f32 v32, v32, v32
    ds_write_b32 v88, v32
    s_waitcnt lgkmcnt(0)
    s_barrier
    ds_read_b64_tr_b16 v[232:233], v251 offset:0
    ds_read_b64_tr_b16 v[234:235], v251 offset:1056
    ds_read_b64_tr_b16 v[236:237], v251 offset:8448
    ds_read_b64_tr_b16 v[238:239], v251 offset:9504
    ds_read_b64_tr_b16 v[240:241], v251 offset:16896
    ds_read_b64_tr_b16 v[242:243], v251 offset:17952
    ds_read_b64_tr_b16 v[244:245], v251 offset:25344
    ds_read_b64_tr_b16 v[246:247], v251 offset:26400
    s_branch L_uv
L_Q1:
    s_setprio 0
    s_barrier
    s_bitcmp1_b32 s58, 0
    s_cbranch_scc1 L_np3
    s_cmp_lt_u32 s59, 12
    s_cbranch_scc1 L_np3
    s_lshr_b32 s66, s58, 1
    s_and_b32 s67, s59, 3
    s_mul_i32 s73, s66, 1327104
    s_mul_i32 s69, s67, 36864
    s_add_u32 s73, s73, s69
    s_add_u32 s73, s73, 1179648
    s_add_u32 s74, s73, 36864
L_p3:
    buffer_load_dwordx4 v[28:31], v8, s[40:43], s73 offen
    s_add_u32 s73, s73, 1024
    s_cmp_lt_u32 s73, s74
    s_cbranch_scc1 L_p3
L_np3:
    s_barrier
    s_barrier
    v_mul_u32_u24 v10, 2112, v3
    v_lshrrev_b32 v11, 2, v2
    v_lshl_add_u32 v10, v11, 8, v10
    v_and_b32 v11, 3, v1
    v_lshl_add_u32 v10, v11, 3, v10
    s_lshl_b32 s66, s3, 5
    v_add_u32 v251, s66, v10
    v_and_b32 v10, 7, v1
    v_mul_u32_u24 v248, 288, v10
    v_lshl_add_u32 v248, v3, 4, v248
    v_add_u32 v248, 41728, v248
    v_lshlrev_b32 v249, 9, v9
    v_lshl_add_u32 v249, v3, 4, v249
    v_mov_b32 v250, 41408
    s_lshl_b32 s65, s54, 13
    s_lshl_b32 s69, s55, 10
    s_add_u32 s65, s65, s69
    s_lshl_b32 s69, s3, 6
    s_add_u32 s65, s65, s69
    s_add_u32 s65, s65, 65536
    s_xor_b32 s66, s53, 0x5a5a0000
    v_mov_b32 v255, s66
L_vw1:
    s_sleep 2
    ds_read_b32 v11, v92
    s_waitcnt lgkmcnt(0)
    v_cmp_eq_u32 vcc, 0, v11
    s_cbranch_vccnz L_vw1
    v_cmp_eq_u32 vcc, 1, v11
    s_cbranch_vccnz L_Qidle
    s_waitcnt vmcnt(0)
    v_add_u32 v10, 36736, v8
    v_lshlrev_b32 v11, 2, v1
    v_add_u32 v11, 38784, v11
    ds_read_b128 v[28:31], v10
    ds_read_b128 v[32:35], v10 offset:1024
    ds_read_b32 v26, v11
    ds_read_b32 v27, v11 offset:256
    s_mov_b32 s66, 5242880
    s_waitcnt lgkmcnt(0)
    buffer_store_dwordx4 v[28:31], v26, s[20:23], s66 offen sc1
    buffer_store_dwordx4 v[32:35], v27, s[20:23], s66 offen sc1
    s_branch L_Qidle
L_Q0:
    v_add_u32 v30, 34432, v30
    v_add_u32 v31, 34432, v31
    s_waitcnt vmcnt(0)
    v_lshlrev_b32 v36, 16, v12
    v_and_b32 v37, 0xffff0000, v12
    v_lshlrev_b32 v38, 16, v13
    v_and_b32 v39, 0xffff0000, v13
    v_lshlrev_b32 v40, 16, v14
    v_and_b32 v41, 0xffff0000, v14
    v_lshlrev_b32 v42, 16, v15
    v_and_b32 v43, 0xffff0000, v15
    v_lshlrev_b32 v44, 16, v16
    v_and_b32 v45, 0xffff0000, v16
    v_lshlrev_b32 v46, 16, v17
    v_and_b32 v47, 0xffff0000, v17
    v_lshlrev_b32 v48, 16, v18
    v_and_b32 v49, 0xffff0000, v18
    v_lshlrev_b32 v50, 16, v19
    v_and_b32 v51, 0xffff0000, v19
    v_lshlrev_b32 v52, 16, v20
    v_and_b32 v53, 0xffff0000, v20
    v_pk_add_f32 v[26:27], v[36:37], v[38:39]
    v_pk_add_f32 v[28:29], v[40:41], v[42:43]
    v_pk_add_f32 v[26:27], v[26:27], v[44:45]
    v_pk_add_f32 v[28:29], v[28:29], v[46:47]
    v_pk_add_f32 v[26:27], v[26:27], v[48:49]
    v_pk_add_f32 v[28:29], v[28:29], v[50:51]
    v_pk_add_f32 v[26:27], v[26:27], v[52:53]
    v_pk_add_f32 v[26:27], v[26:27], v[28:29]
    v_add_f32 v26, v26, v27
    s_nop 1
    v_add_f32_dpp v26, v26, v26 quad_perm:[1,0,3,2] row_mask:0xf bank_mask:0xf
    s_nop 1
    v_add_f32_dpp v26, v26, v26 quad_perm:[2,3,0,1] row_mask:0xf bank_mask:0xf
    s_nop 1
    v_add_f32_dpp v26, v26, v26 row_ror:4 row_mask:0xf bank_mask:0xf
    s_nop 1
    v_add_f32_dpp v26, v26, v26 row_ror:8 row_mask:0xf bank_mask:0xf
    v_mov_b32 v27, v26
    s_nop 1
    v_permlane16_swap_b32 v26, v27
    v_add_f32 v26, v26, v27
    v_mul_f32 v26, -0.001736111111111111, v26
    v_pk_add_f32 v[60:61], v[36:37], v[26:27] op_sel_hi:[1,0]
    v_pk_add_f32 v[62:63], v[38:39], v[26:27] op_sel_hi:[1,0]
    v_pk_add_f32 v[64:65], v[40:41], v[26:27] op_sel_hi:[1,0]
    v_pk_add_f32 v[66:67], v[42:43], v[26:27] op_sel_hi:[1,0]
    v_pk_add_f32 v[68:69], v[44:45], v[26:27] op_sel_hi:[1,0]
    v_pk_add_f32 v[70:71], v[46:47], v[26:27] op_sel_hi:[1,0]
    v_pk_add_f32 v[72:73], v[48:49], v[26:27] op_sel_hi:[1,0]
    v_pk_add_f32 v[74:75], v[50:51], v[26:27] op_sel_hi:[1,0]
    v_pk_add_f32 v[76:77], v[52:53], v[26:27] op_sel_hi:[1,0]
    v_pk_mul_f32 v[28:29], v[60:61], v[60:61]
    v_pk_mul_f32 v[32:33], v[62:63], v[62:63]
    v_pk_fma_f32 v[28:29], v[64:65], v[64:65], v[28:29]
    v_pk_fma_f32 v[32:33], v[66:67], v[66:67], v[32:33]
    v_pk_fma_f32 v[28:29], v[68:69], v[68:69], v[28:29]
    v_pk_fma_f32 v[32:33], v[70:71], v[70:71], v[32:33]
    v_pk_fma_f32 v[28:29], v[72:73], v[72:73], v[28:29]
    v_pk_fma_f32 v[32:33], v[74:75], v[74:75], v[32:33]
    v_pk_fma_f32 v[28:29], v[76:77], v[76:77], v[28:29]
    v_pk_add_f32 v[28:29], v[28:29], v[32:33]
    v_add_f32 v28, v28, v29
    v_cvt_pk_bf16_f32 v22, v26, v26
    v_and_b32 v22, 0xffff0000, v22
    v_add_f32_dpp v28, v28, v28 quad_perm:[1,0,3,2] row_mask:0xf bank_mask:0xf
    v_pk_add_f32 v[36:37], v[36:37], v[22:23] op_sel_hi:[1,0]
    v_pk_add_f32 v[38:39], v[38:39], v[22:23] op_sel_hi:[1,0]
    v_add_f32_dpp v28, v28, v28 quad_perm:[2,3,0,1] row_mask:0xf bank_mask:0xf
    v_pk_add_f32 v[40:41], v[40:41], v[22:23] op_sel_hi:[1,0]
    v_pk_add_f32 v[42:43], v[42:43], v[22:23] op_sel_hi:[1,0]
    v_add_f32_dpp v28, v28, v28 row_ror:4 row_mask:0xf bank_mask:0xf
    v_pk_add_f32 v[44:45], v[44:45], v[22:23] op_sel_hi:[1,0]
    v_pk_add_f32 v[46:47], v[46:47], v[22:23] op_sel_hi:[1,0]
    v_add_f32_dpp v28, v28, v28 row_ror:8 row_mask:0xf bank_mask:0xf
    v_pk_add_f32 v[48:49], v[48:49], v[22:23] op_sel_hi:[1,0]
    v_pk_add_f32 v[50:51], v[50:51], v[22:23] op_sel_hi:[1,0]
    v_mov_b32 v29, v28
    v_pk_add_f32 v[52:53], v[52:53], v[22:23] op_sel_hi:[1,0]
    v_cvt_pk_bf16_f32 v12, v36, v37
    v_permlane16_swap_b32 v28, v29
    v_add_f32 v28, v28, v29
    v_mul_f32 v28, 0.001736111111111111, v28
    v_cvt_pk_bf16_f32 v28, v28, v28
    v_and_b32 v28, 0xffff0000, v28
    v_add_f32 v28, 0x3727c5ac, v28
    v_cvt_pk_bf16_f32 v28, v28, v28
    v_and_b32 v28, 0xffff0000, v28
    v_sqrt_f32 v28, v28
    v_cvt_pk_bf16_f32 v13, v38, v39
    v_cvt_pk_bf16_f32 v28, v28, v28
    v_and_b32 v28, 0xffff0000, v28
    v_rcp_f32 v24, v28
    v_cvt_pk_bf16_f32 v14, v40, v41
    v_cvt_pk_bf16_f32 v15, v42, v43
    v_cvt_pk_bf16_f32 v16, v44, v45
    v_cvt_pk_bf16_f32 v17, v46, v47
    v_cvt_pk_bf16_f32 v18, v48, v49
    v_cvt_pk_bf16_f32 v19, v50, v51
    v_cvt_pk_bf16_f32 v20, v52, v53
    v_lshlrev_b32 v36, 16, v12
    v_and_b32 v37, 0xffff0000, v12
    v_lshlrev_b32 v38, 16, v13
    v_and_b32 v39, 0xffff0000, v13
    v_lshlrev_b32 v40, 16, v14
    v_and_b32 v41, 0xffff0000, v14
    v_lshlrev_b32 v42, 16, v15
    v_and_b32 v43, 0xffff0000, v15
    v_lshlrev_b32 v44, 16, v16
    v_and_b32 v45, 0xffff0000, v16
    v_lshlrev_b32 v46, 16, v17
    v_and_b32 v47, 0xffff0000, v17
    v_lshlrev_b32 v48, 16, v18
    v_and_b32 v49, 0xffff0000, v18
    v_lshlrev_b32 v50, 16, v19
    v_and_b32 v51, 0xffff0000, v19
    v_lshlrev_b32 v52, 16, v20
    v_and_b32 v53, 0xffff0000, v20
    v_pk_mul_f32 v[36:37], v[36:37], v[24:25] op_sel_hi:[1,0]
    v_cvt_pk_bf16_f32 v12, v36, v37
    v_pk_mul_f32 v[38:39], v[38:39], v[24:25] op_sel_hi:[1,0]
    v_cvt_pk_bf16_f32 v13, v38, v39
    v_pk_mul_f32 v[40:41], v[40:41], v[24:25] op_sel_hi:[1,0]
    v_cvt_pk_bf16_f32 v14, v40, v41
    v_pk_mul_f32 v[42:43], v[42:43], v[24:25] op_sel_hi:[1,0]
    v_cvt_pk_bf16_f32 v15, v42, v43
    ds_write_b128 v30, v[12:15]
    v_pk_mul_f32 v[44:45], v[44:45], v[24:25] op_sel_hi:[1,0]
    v_cvt_pk_bf16_f32 v16, v44, v45
    v_pk_mul_f32 v[46:47], v[46:47], v[24:25] op_sel_hi:[1,0]
    v_cvt_pk_bf16_f32 v17, v46, v47
    v_pk_mul_f32 v[48:49], v[48:49], v[24:25] op_sel_hi:[1,0]
    v_cvt_pk_bf16_f32 v18, v48, v49
    v_pk_mul_f32 v[50:51], v[50:51], v[24:25] op_sel_hi:[1,0]
    v_cvt_pk_bf16_f32 v19, v50, v51
    ds_write_b128 v30, v[16:19] offset:512
    v_pk_mul_f32 v[52:53], v[52:53], v[24:25] op_sel_hi:[1,0]
    v_cvt_pk_bf16_f32 v20, v52, v53
    ds_write_b32 v31, v20 offset:1024
    ds_write_b32 v34, v34
    s_setprio 0
    s_load_dword s53, s[20:21], 0
    s_load_dwordx2 s[32:33], s[0:1], 56
    s_load_dwordx2 s[44:45], s[0:1], 80
    s_load_dwordx2 s[48:49], s[0:1], 88
    s_mov_b32 s22, 268435456
    s_mov_b32 s23, 0x20000
    s_mov_b32 s34, 5308416
    s_mov_b32 s35, 0x20000
    s_mov_b32 s46, 1152
    s_mov_b32 s47, 0x20000
    s_mov_b32 s50, 2304
    s_mov_b32 s51, 0x20000
    s_lshl_b32 s65, s59, 3
    s_add_u32 s65, s65, s58
    s_and_b32 s52, s3, 3
    s_and_b32 s69, s59, 3
    s_lshl_b32 s54, s58, 2
    s_add_u32 s54, s54, s69
    s_lshr_b32 s55, s59, 2
    v_and_b32 v2, 15, v1
    v_lshrrev_b32 v3, 4, v1
    v_lshlrev_b32 v8, 4, v1
    v_bfe_u32 v9, v1, 2, 1
    v_and_b32 v10, 3, v1
    v_lshlrev_b32 v10, 4, v10
    v_mov_b32 v4, 0xffff
    v_mov_b32 v5, 0
    v_lshlrev_b64 v[4:5], v10, v[4:5]
    v_bfe_i32 v10, v1, 3, 1
    v_and_b32 v6, v10, v4
    v_and_b32 v7, v10, v5
    v_xor_b32 v4, v4, v6
    v_xor_b32 v5, v5, v7
    s_mov_b32 s60, 0x07060501
    s_mov_b32 s61, 0x07060502
    s_mov_b32 s62, 0x07060503
    s_mov_b32 s63, 0x04000c0c
    s_mov_b32 s64, 0x0706000c
    s_mov_b32 s100, 0x01000100
    s_mov_b32 s101, 0x03020302
    s_and_b32 s56, s58, 1
    s_lshr_b32 s67, s58, 1
    s_and_b32 s66, s3, 1
    s_lshl_b32 s71, s59, 1
    s_add_u32 s71, s71, s66
    s_cmp_eq_u32 s56, 0
    s_cselect_b32 s66, 64, 52
    s_mul_i32 s68, s71, s66
    s_lshr_b32 s68, s68, 8
    s_add_u32 s66, s56, 4
    s_mul_i32 s66, s66, s68
    s_sub_u32 s72, s71, s66
    s_cmp_eq_u32 s72, 4
    s_cselect_b32 s76, 5242880, 0
    s_lshl_b32 s72, s72, 0
    s_mul_i32 s69, s67, 9
    s_add_u32 s72, s72, s69
    s_lshl_b32 s69, s56, 2
    s_add_u32 s72, s72, s69
    v_mul_u32_u24 v14, 9216, v3
    v_lshl_add_u32 v14, v2, 4, v14
    s_mul_i32 s73, s68, 884736
    s_lshl_b32 s69, s72, 8
    s_add_u32 s73, s73, s69
    s_mul_i32 s74, s72, 6144
    s_lshl_b32 s69, s68, 10
    s_add_u32 s74, s74, s69
    s_add_u32 s74, s74, s76
    s_add_u32 s74, s74, 720896
    s_mul_i32 s66, s68, 192
    s_add_u32 s66, s66, 34432
    v_mul_u32_u24 v10, 2, v3
    v_mul_u32_u24 v11, 1152, v9
    v_add3_u32 v15, v10, v11, s66
    s_mul_i32 s75, s56, 6
    s_add_u32 s75, s75, 24
    v_mov_b32 v92, 41408
    s_waitcnt lgkmcnt(0)
    s_add_u32 s53, s53, 1
    s_barrier
    s_barrier
    s_barrier
    s_barrier
    s_branch L_Qw1
L_Q3b:
    s_load_dword s53, s[20:21], 0
    s_load_dwordx2 s[32:33], s[0:1], 56
    s_load_dwordx2 s[44:45], s[0:1], 80
    s_load_dwordx2 s[48:49], s[0:1], 88
    s_mov_b32 s22, 268435456
    s_mov_b32 s23, 0x20000
    s_mov_b32 s34, 5308416
    s_mov_b32 s35, 0x20000
    s_mov_b32 s6, 2304
    s_mov_b32 s7, 0x20000
    s_mov_b32 s46, 1152
    s_mov_b32 s47, 0x20000
    s_mov_b32 s50, 2304
    s_mov_b32 s51, 0x20000
    s_lshl_b32 s65, s59, 3
    s_add_u32 s65, s65, s58
    s_and_b32 s52, s3, 3
    s_and_b32 s69, s59, 3
    s_lshl_b32 s54, s58, 2
    s_add_u32 s54, s54, s69
    s_lshr_b32 s55, s59, 2
    v_lshlrev_b32 v8, 4, v1
    v_bfe_u32 v9, v1, 2, 1
    v_and_b32 v10, 3, v1
    v_lshlrev_b32 v10, 4, v10
    v_mov_b32 v4, 0xffff
    v_mov_b32 v5, 0
    v_lshlrev_b64 v[4:5], v10, v[4:5]
    v_bfe_i32 v10, v1, 3, 1
    v_and_b32 v6, v10, v4
    v_and_b32 v7, v10, v5
    v_xor_b32 v4, v4, v6
    v_xor_b32 v5, v5, v7
    s_mov_b32 s60, 0x07060501
    s_mov_b32 s61, 0x07060502
    s_mov_b32 s62, 0x07060503
    s_mov_b32 s63, 0x04000c0c
    s_mov_b32 s64, 0x0706000c
    s_mov_b32 s100, 0x01000100
    s_mov_b32 s101, 0x03020302
    s_and_b32 s56, s58, 1
    s_lshr_b32 s67, s58, 1
    s_and_b32 s66, s3, 1
    s_lshl_b32 s71, s59, 1
    s_add_u32 s71, s71, s66
    s_cmp_eq_u32 s56, 0
    s_cselect_b32 s66, 64, 52
    s_mul_i32 s68, s71, s66
    s_lshr_b32 s68, s68, 8
    s_add_u32 s66, s56, 4
    s_mul_i32 s66, s66, s68
    s_sub_u32 s72, s71, s66
    s_cmp_eq_u32 s72, 4
    s_cselect_b32 s76, 5242880, 0
    s_lshl_b32 s72, s72, 0
    s_mul_i32 s69, s67, 9
    s_add_u32 s72, s72, s69
    s_lshl_b32 s69, s56, 2
    s_add_u32 s72, s72, s69
    v_mul_u32_u24 v14, 9216, v3
    v_lshl_add_u32 v14, v2, 4, v14
    s_mul_i32 s73, s68, 884736
    s_lshl_b32 s69, s72, 8
    s_add_u32 s73, s73, s69
    s_mul_i32 s74, s72, 6144
    s_lshl_b32 s69, s68, 10
    s_add_u32 s74, s74, s69
    s_add_u32 s74, s74, s76
    s_add_u32 s74, s74, 720896
    s_mul_i32 s66, s68, 192
    s_add_u32 s66, s66, 34432
    v_mul_u32_u24 v10, 2, v3
    v_mul_u32_u24 v11, 1152, v9
    v_add3_u32 v15, v10, v11, s66
    s_mul_i32 s75, s56, 6
    s_add_u32 s75, s75, 24
    v_mov_b32 v92, 41408
    s_waitcnt lgkmcnt(0)
    s_add_u32 s53, s53, 1
    s_barrier
    buffer_load_dwordx4 v12, s[16:19], s77 offen nt lds
    s_add_u32 m0, m0, 1056
    s_add_u32 s77, s77, 32768
    buffer_load_dwordx4 v12, s[16:19], s77 offen nt lds
    s_add_u32 m0, m0, 1056
    s_add_u32 s77, s77, 32768
    buffer_load_dwordx4 v12, s[16:19], s77 offen nt lds
    s_add_u32 m0, m0, 1056
    s_add_u32 s77, s77, 32768
    buffer_load_dwordx4 v12, s[16:19], s77 offen nt lds
    s_add_u32 m0, m0, 1056
    s_add_u32 s77, s77, 32768
    s_waitcnt vmcnt(16)
    s_barrier
    s_barrier
    buffer_load_dwordx4 v12, s[16:19], s77 offen nt lds
    s_add_u32 m0, m0, 1056
    s_add_u32 s77, s77, 32768
    buffer_load_dwordx4 v12, s[16:19], s77 offen nt lds
    s_add_u32 m0, m0, 1056
    s_add_u32 s77, s77, 32768
    buffer_load_dwordx4 v12, s[16:19], s77 offen nt lds
    s_add_u32 m0, m0, 1056
    s_add_u32 s77, s77, 32768
    buffer_load_dwordx4 v12, s[16:19], s77 offen nt lds
    s_add_u32 m0, m0, 1056
    s_add_u32 s77, s77, 32768
    buffer_load_dwordx4 v12, s[16:19], s77 offen nt lds
    s_add_u32 m0, m0, 1056
    s_add_u32 s77, s77, 32768
    buffer_load_dwordx4 v12, s[16:19], s77 offen nt lds
    s_add_u32 m0, m0, 1056
    s_add_u32 s77, s77, 32768
    buffer_load_dwordx4 v12, s[16:19], s77 offen nt lds
    s_add_u32 m0, m0, 1056
    s_add_u32 s77, s77, 32768
    buffer_load_dwordx4 v12, s[16:19], s77 offen nt lds
    s_waitcnt vmcnt(4)
    s_barrier
    s_waitcnt vmcnt(0)
L_Qw1:
    s_barrier
    s_cmp_ge_u32 s71, s75
    s_cbranch_scc1 L_now1
    buffer_load_dwordx4 v[96:99], v14, s[32:35], s73 offen nt
    s_add_u32 s73, s73, 36864
    buffer_load_dwordx4 v[100:103], v14, s[32:35], s73 offen nt
    s_add_u32 s73, s73, 36864
    buffer_load_dwordx4 v[104:107], v14, s[32:35], s73 offen nt
    s_add_u32 s73, s73, 36864
    buffer_load_dwordx4 v[108:111], v14, s[32:35], s73 offen nt
    s_add_u32 s73, s73, 36864
    buffer_load_dwordx4 v[112:115], v14, s[32:35], s73 offen nt
    s_add_u32 s73, s73, 36864
    buffer_load_dwordx4 v[116:119], v14, s[32:35], s73 offen nt
    s_add_u32 s73, s73, 36864
    buffer_load_dwordx4 v[120:123], v14, s[32:35], s73 offen nt
    s_add_u32 s73, s73, 36864
    buffer_load_dwordx4 v[124:127], v14, s[32:35], s73 offen nt
    s_add_u32 s73, s73, 36864
    s_barrier
    s_barrier
    v_lshlrev_b32 v10, 6, v1
    s_bfm_b64 exec, 16, 0
    buffer_load_dword v10, v10, s[20:23], s74 offen sc1
    s_mov_b64 exec, -1
    buffer_load_dwordx4 v[128:131], v14, s[32:35], s73 offen nt
    s_add_u32 s73, s73, 36864
    buffer_load_dwordx4 v[132:135], v14, s[32:35], s73 offen nt
    s_add_u32 s73, s73, 36864
    buffer_load_dwordx4 v[136:139], v14, s[32:35], s73 offen nt
    s_add_u32 s73, s73, 36864
    buffer_load_dwordx4 v[140:143], v14, s[32:35], s73 offen nt
    s_add_u32 s73, s73, 36864
    buffer_load_dwordx4 v[144:147], v14, s[32:35], s73 offen nt
    s_add_u32 s73, s73, 36864
    buffer_load_dwordx4 v[148:151], v14, s[32:35], s73 offen nt
    s_add_u32 s73, s73, 36864
    buffer_load_dwordx4 v[152:155], v14, s[32:35], s73 offen nt
    s_add_u32 s73, s73, 36864
    buffer_load_dwordx4 v[156:159], v14, s[32:35], s73 offen nt
    s_add_u32 s73, s73, 36864
    buffer_load_dwordx4 v[160:163], v14, s[32:35], s73 offen nt
    s_add_u32 s73, s73, 36864
    buffer_load_dwordx4 v[164:167], v14, s[32:35], s73 offen nt
    s_add_u32 s73, s73, 36864
    buffer_load_dwordx4 v[168:171], v14, s[32:35], s73 offen nt
    s_add_u32 s73, s73, 36864
    buffer_load_dwordx4 v[172:175], v14, s[32:35], s73 offen nt
    s_add_u32 s73, s73, 36864
    buffer_load_dwordx4 v[176:179], v14, s[32:35], s73 offen nt
    s_add_u32 s73, s73, 36864
    buffer_load_dwordx4 v[180:183], v14, s[32:35], s73 offen nt
    s_add_u32 s73, s73, 36864
    buffer_load_dwordx4 v[184:187], v14, s[32:35], s73 offen nt
    s_add_u32 s73, s73, 36864
    buffer_load_dwordx4 v[188:191], v14, s[32:35], s73 offen nt
    s_add_u32 s73, s73, 36864
    s_barrier
    ds_read_u16 v36, v15 offset:0
    ds_read_u16 v37, v15 offset:8
    ds_read_u16 v38, v15 offset:16
    ds_read_u16 v39, v15 offset:24
    ds_read_u16 v40, v15 offset:32
    ds_read_u16 v41, v15 offset:40
    ds_read_u16 v42, v15 offset:48
    ds_read_u16 v43, v15 offset:56
    ds_read_u16 v44, v15 offset:64
    ds_read_u16 v45, v15 offset:72
    ds_read_u16 v46, v15 offset:80
    ds_read_u16 v47, v15 offset:88
    ds_read_u16 v48, v15 offset:96
    ds_read_u16 v49, v15 offset:104
    ds_read_u16 v50, v15 offset:112
    ds_read_u16 v51, v15 offset:120
    ds_read_u16 v52, v15 offset:128
    ds_read_u16 v53, v15 offset:136
    ds_read_u16 v54, v15 offset:144
    ds_read_u16 v55, v15 offset:152
    ds_read_u16 v56, v15 offset:160
    ds_read_u16 v57, v15 offset:168
    ds_read_u16 v58, v15 offset:176
    ds_read_u16 v59, v15 offset:184
    v_mov_b32 v83, s53
    s_waitcnt lgkmcnt(0)
    v_perm_b32 v66, v36, v36, s100
    v_and_b32 v68, v66, v4
    v_and_b32 v69, v66, v5
    v_and_b32 v70, v66, v6
    v_and_b32 v71, v66, v7
    v_perm_b32 v66, v37, v37, s100
    v_and_b32 v72, v66, v4
    v_and_b32 v73, v66, v5
    v_and_b32 v74, v66, v6
    v_and_b32 v75, v66, v7
    s_waitcnt vmcnt(23)
    v_mfma_f32_16x16x32_bf16 v[76:79], v[68:71], v[96:99], 0
    v_perm_b32 v66, v38, v38, s100
    v_and_b32 v68, v66, v4
    v_and_b32 v69, v66, v5
    v_and_b32 v70, v66, v6
    v_and_b32 v71, v66, v7
    s_waitcnt vmcnt(22)
    v_mfma_f32_16x16x32_bf16 v[76:79], v[72:75], v[100:103], v[76:79]
    v_perm_b32 v66, v39, v39, s100
    v_and_b32 v72, v66, v4
    v_and_b32 v73, v66, v5
    v_and_b32 v74, v66, v6
    v_and_b32 v75, v66, v7
    s_waitcnt vmcnt(21)
    v_mfma_f32_16x16x32_bf16 v[76:79], v[68:71], v[104:107], v[76:79]
    v_perm_b32 v66, v40, v40, s100
    v_and_b32 v68, v66, v4
    v_and_b32 v69, v66, v5
    v_and_b32 v70, v66, v6
    v_and_b32 v71, v66, v7
    s_waitcnt vmcnt(20)
    v_mfma_f32_16x16x32_bf16 v[76:79], v[72:75], v[108:111], v[76:79]
    v_perm_b32 v66, v41, v41, s100
    v_and_b32 v72, v66, v4
    v_and_b32 v73, v66, v5
    v_and_b32 v74, v66, v6
    v_and_b32 v75, v66, v7
    s_waitcnt vmcnt(19)
    v_mfma_f32_16x16x32_bf16 v[76:79], v[68:71], v[112:115], v[76:79]
    v_perm_b32 v66, v42, v42, s100
    v_and_b32 v68, v66, v4
    v_and_b32 v69, v66, v5
    v_and_b32 v70, v66, v6
    v_and_b32 v71, v66, v7
    s_waitcnt vmcnt(18)
    v_mfma_f32_16x16x32_bf16 v[76:79], v[72:75], v[116:119], v[76:79]
    v_perm_b32 v66, v43, v43, s100
    v_and_b32 v72, v66, v4
    v_and_b32 v73, v66, v5
    v_and_b32 v74, v66, v6
    v_and_b32 v75, v66, v7
    s_waitcnt vmcnt(17)
    v_mfma_f32_16x16x32_bf16 v[76:79], v[68:71], v[120:123], v[76:79]
    v_perm_b32 v66, v44, v44, s100
    v_and_b32 v68, v66, v4
    v_and_b32 v69, v66, v5
    v_and_b32 v70, v66, v6
    v_and_b32 v71, v66, v7
    s_waitcnt vmcnt(16)
    v_mfma_f32_16x16x32_bf16 v[76:79], v[72:75], v[124:127], v[76:79]
    v_perm_b32 v66, v45, v45, s100
    v_and_b32 v72, v66, v4
    v_and_b32 v73, v66, v5
    v_and_b32 v74, v66, v6
    v_and_b32 v75, v66, v7
    s_waitcnt vmcnt(15)
    v_mfma_f32_16x16x32_bf16 v[76:79], v[68:71], v[128:131], v[76:79]
    v_perm_b32 v66, v46, v46, s100
    v_and_b32 v68, v66, v4
    v_and_b32 v69, v66, v5
    v_and_b32 v70, v66, v6
    v_and_b32 v71, v66, v7
    s_waitcnt vmcnt(14)
    v_mfma_f32_16x16x32_bf16 v[76:79], v[72:75], v[132:135], v[76:79]
    v_perm_b32 v66, v47, v47, s100
    v_and_b32 v72, v66, v4
    v_and_b32 v73, v66, v5
    v_and_b32 v74, v66, v6
    v_and_b32 v75, v66, v7
    s_waitcnt vmcnt(13)
    v_mfma_f32_16x16x32_bf16 v[76:79], v[68:71], v[136:139], v[76:79]
    v_perm_b32 v66, v48, v48, s100
    v_and_b32 v68, v66, v4
    v_and_b32 v69, v66, v5
    v_and_b32 v70, v66, v6
    v_and_b32 v71, v66, v7
    s_waitcnt vmcnt(12)
    v_mfma_f32_16x16x32_bf16 v[76:79], v[72:75], v[140:143], v[76:79]
    v_perm_b32 v66, v49, v49, s100
    v_and_b32 v72, v66, v4
    v_and_b32 v73, v66, v5
    v_and_b32 v74, v66, v6
    v_and_b32 v75, v66, v7
    s_waitcnt vmcnt(11)
    v_mfma_f32_16x16x32_bf16 v[76:79], v[68:71], v[144:147], v[76:79]
    v_perm_b32 v66, v50, v50, s100
    v_and_b32 v68, v66, v4
    v_and_b32 v69, v66, v5
    v_and_b32 v70, v66, v6
    v_and_b32 v71, v66, v7
    s_waitcnt vmcnt(10)
    v_mfma_f32_16x16x32_bf16 v[76:79], v[72:75], v[148:151], v[76:79]
    v_perm_b32 v66, v51, v51, s100
    v_and_b32 v72, v66, v4
    v_and_b32 v73, v66, v5
    v_and_b32 v74, v66, v6
    v_and_b32 v75, v66, v7
    s_waitcnt vmcnt(9)
    v_mfma_f32_16x16x32_bf16 v[76:79], v[68:71], v[152:155], v[76:79]
    v_perm_b32 v66, v52, v52, s100
    v_and_b32 v68, v66, v4
    v_and_b32 v69, v66, v5
    v_and_b32 v70, v66, v6
    v_and_b32 v71, v66, v7
    s_waitcnt vmcnt(8)
    v_mfma_f32_16x16x32_bf16 v[76:79], v[72:75], v[156:159], v[76:79]
    v_perm_b32 v66, v53, v53, s100
    v_and_b32 v72, v66, v4
    v_and_b32 v73, v66, v5
    v_and_b32 v74, v66, v6
    v_and_b32 v75, v66, v7
    s_waitcnt vmcnt(7)
    v_mfma_f32_16x16x32_bf16 v[76:79], v[68:71], v[160:163], v[76:79]
    v_perm_b32 v66, v54, v54, s100
    v_and_b32 v68, v66, v4
    v_and_b32 v69, v66, v5
    v_and_b32 v70, v66, v6
    v_and_b32 v71, v66, v7
    s_waitcnt vmcnt(6)
    v_mfma_f32_16x16x32_bf16 v[76:79], v[72:75], v[164:167], v[76:79]
    v_perm_b32 v66, v55, v55, s100
    v_and_b32 v72, v66, v4
    v_and_b32 v73, v66, v5
    v_and_b32 v74, v66, v6
    v_and_b32 v75, v66, v7
    s_waitcnt vmcnt(5)
    v_mfma_f32_16x16x32_bf16 v[76:79], v[68:71], v[168:171], v[76:79]
    v_perm_b32 v66, v56, v56, s100
    v_and_b32 v68, v66, v4
    v_and_b32 v69, v66, v5
    v_and_b32 v70, v66, v6
    v_and_b32 v71, v66, v7
    s_waitcnt vmcnt(4)
    v_mfma_f32_16x16x32_bf16 v[76:79], v[72:75], v[172:175], v[76:79]
    v_perm_b32 v66, v57, v57, s100
    v_and_b32 v72, v66, v4
    v_and_b32 v73, v66, v5
    v_and_b32 v74, v66, v6
    v_and_b32 v75, v66, v7
    s_waitcnt vmcnt(3)
    v_mfma_f32_16x16x32_bf16 v[76:79], v[68:71], v[176:179], v[76:79]
    v_perm_b32 v66, v58, v58, s100
    v_and_b32 v68, v66, v4
    v_and_b32 v69, v66, v5
    v_and_b32 v70, v66, v6
    v_and_b32 v71, v66, v7
    s_waitcnt vmcnt(2)
    v_mfma_f32_16x16x32_bf16 v[76:79], v[72:75], v[180:183], v[76:79]
    v_perm_b32 v66, v59, v59, s100
    v_and_b32 v72, v66, v4
    v_and_b32 v73, v66, v5
    v_and_b32 v74, v66, v6
    v_and_b32 v75, v66, v7
    s_waitcnt vmcnt(1)
    v_mfma_f32_16x16x32_bf16 v[76:79], v[68:71], v[184:187], v[76:79]
    s_waitcnt vmcnt(0)
    v_mfma_f32_16x16x32_bf16 v[76:79], v[72:75], v[188:191], v[76:79]
    s_nop 7
    v_perm_b32 v80, v76, v79, s60
    v_perm_b32 v81, v77, v79, s61
    v_perm_b32 v82, v78, v79, s62
    s_cmp_lg_u32 s76, 0
    s_cbranch_scc1 L_w5
    buffer_store_dwordx4 v[80:83], v8, s[20:23], s74 offen
    s_barrier
    v_mul_u32_u24 v10, 2112, v3
    v_lshrrev_b32 v11, 2, v2
    v_lshl_add_u32 v10, v11, 8, v10
    v_and_b32 v11, 3, v1
    v_lshl_add_u32 v10, v11, 3, v10
    s_lshl_b32 s66, s3, 5
    v_add_u32 v251, s66, v10
    v_and_b32 v10, 7, v1
    v_mul_u32_u24 v248, 288, v10
    v_lshl_add_u32 v248, v3, 4, v248
    v_add_u32 v248, 41728, v248
    v_lshlrev_b32 v249, 9, v9
    v_lshl_add_u32 v249, v3, 4, v249
    v_mov_b32 v250, 41408
    s_lshl_b32 s65, s54, 13
    s_lshl_b32 s69, s55, 10
    s_add_u32 s65, s65, s69
    s_lshl_b32 s69, s3, 6
    s_add_u32 s65, s65, s69
    s_add_u32 s65, s65, 65536
    s_xor_b32 s66, s53, 0x5a5a0000
    v_mov_b32 v255, s66
L_vw0:
    s_sleep 2
    ds_read_b32 v11, v92
    s_waitcnt lgkmcnt(0)
    v_cmp_eq_u32 vcc, 0, v11
    s_cbranch_vccnz L_vw0
    v_cmp_eq_u32 vcc, 1, v11
    s_cbranch_vccnz L_Qidle
    s_add_u32 s74, s74, 5242880
    buffer_store_dwordx4 v[80:83], v8, s[20:23], s74 offen sc1
    s_branch L_Qidle
L_w5:
    buffer_store_dwordx4 v[80:83], v8, s[20:23], s74 offen sc1
    s_branch L_w6
L_now1:
    s_barrier
    s_barrier
    s_barrier
L_w6:
    s_barrier
    v_mul_u32_u24 v10, 2112, v3
    v_lshrrev_b32 v11, 2, v2
    v_lshl_add_u32 v10, v11, 8, v10
    v_and_b32 v11, 3, v1
    v_lshl_add_u32 v10, v11, 3, v10
    s_lshl_b32 s66, s3, 5
    v_add_u32 v251, s66, v10
    v_and_b32 v10, 7, v1
    v_mul_u32_u24 v248, 288, v10
    v_lshl_add_u32 v248, v3, 4, v248
    v_add_u32 v248, 41728, v248
    v_lshlrev_b32 v249, 9, v9
    v_lshl_add_u32 v249, v3, 4, v249
    v_mov_b32 v250, 41408
    s_lshl_b32 s65, s54, 13
    s_lshl_b32 s69, s55, 10
    s_add_u32 s65, s65, s69
    s_lshl_b32 s69, s3, 6
    s_add_u32 s65, s65, s69
    s_add_u32 s65, s65, 65536
    s_xor_b32 s66, s53, 0x5a5a0000
    v_mov_b32 v255, s66
L_Qidle:
    s_setprio 2
    s_barrier
    s_barrier
    ds_read_b64_tr_b16 v[232:233], v251 offset:0
    ds_read_b64_tr_b16 v[234:235], v251 offset:1056
    ds_read_b64_tr_b16 v[236:237], v251 offset:8448
    ds_read_b64_tr_b16 v[238:239], v251 offset:9504
    ds_read_b64_tr_b16 v[240:241], v251 offset:16896
    ds_read_b64_tr_b16 v[242:243], v251 offset:17952
    ds_read_b64_tr_b16 v[244:245], v251 offset:25344
    ds_read_b64_tr_b16 v[246:247], v251 offset:26400
    s_branch L_uv
L_Q47:
    s_waitcnt lgkmcnt(0)
    s_load_dword s53, s[20:21], 0
    s_load_dwordx2 s[24:25], s[0:1], 32
    s_load_dwordx2 s[44:45], s[0:1], 80
    s_load_dwordx2 s[48:49], s[0:1], 88
    s_mov_b32 s22, 268435456
    s_mov_b32 s23, 0x20000
    s_mov_b32 s26, 4194304
    s_mov_b32 s27, 0x20000
    s_mov_b32 s6, 2304
    s_mov_b32 s7, 0x20000
    s_mov_b32 s46, 1152
    s_mov_b32 s47, 0x20000
    s_mov_b32 s50, 2304
    s_mov_b32 s51, 0x20000
    s_lshl_b32 s65, s59, 3
    s_add_u32 s65, s65, s58
    s_and_b32 s52, s3, 3
    s_and_b32 s69, s59, 3
    s_lshl_b32 s54, s58, 2
    s_add_u32 s54, s54, s69
    s_lshr_b32 s55, s59, 2
    v_and_b32 v2, 15, v1
    v_lshrrev_b32 v3, 4, v1
    v_lshlrev_b32 v8, 4, v1
    v_bfe_u32 v9, v1, 2, 1
    v_and_b32 v10, 3, v1
    v_lshlrev_b32 v10, 4, v10
    v_mov_b32 v4, 0xffff
    v_mov_b32 v5, 0
    v_lshlrev_b64 v[4:5], v10, v[4:5]
    v_bfe_i32 v10, v1, 3, 1
    v_and_b32 v6, v10, v4
    v_and_b32 v7, v10, v5
    v_xor_b32 v4, v4, v6
    v_xor_b32 v5, v5, v7
    s_mov_b32 s60, 0x07060501
    s_mov_b32 s61, 0x07060502
    s_mov_b32 s62, 0x07060503
    s_mov_b32 s63, 0x04000c0c
    s_mov_b32 s64, 0x0706000c
    s_mov_b32 s100, 0x01000100
    s_mov_b32 s101, 0x03020302
    s_cmp_lg_u32 s52, 0
    s_cbranch_scc1 L_nopw
    s_lshl_b32 s67, s54, 10
    s_lshl_b32 s69, s55, 8
    s_add_u32 s67, s67, s69
    s_add_u32 s67, s67, 327680
    v_and_b32 v10, 3, v1
    v_lshlrev_b32 v10, 6, v10
    v_lshl_add_u32 v24, v9, 15, v10
    s_mov_b64 exec, 0xff
    buffer_load_dword v24, v24, s[20:23], s67 offen sc1
    s_mov_b64 exec, -1
L_nopw:
    v_lshlrev_b32 v12, 10, v3
    v_lshl_add_u32 v12, v2, 4, v12
    v_add_u32 v15, 4096, v12
    s_lshl_b32 s75, s54, 13
    s_lshl_b32 s69, s52, 8
    s_add_u32 s75, s75, s69
    s_add_u32 s75, s75, 65536
    s_and_b32 s66, s52, 1
    s_lshr_b32 s67, s52, 1
    s_mul_i32 s68, s66, 288
    s_lshl_b32 s69, s67, 3
    s_add_u32 s68, s68, s69
    s_add_u32 s68, s68, 33792
    v_lshlrev_b32 v13, 1, v3
    v_lshl_add_u32 v13, v2, 4, v13
    v_add_u32 v13, s68, v13
    s_lshl_b32 s74, s55, 20
    s_lshl_b32 s69, s67, 19
    s_add_u32 s74, s74, s69
    s_lshl_b32 s69, s66, 16
    s_add_u32 s74, s74, s69
    s_lshl_b32 s69, s54, 8
    s_add_u32 s74, s74, s69
    v_lshlrev_b32 v85, 17, v3
    v_lshl_add_u32 v85, v2, 4, v85
    s_mul_i32 m0, s52, 8448
    v_and_b32 v10, 1, v3
    v_lshrrev_b32 v11, 1, v3
    v_lshlrev_b32 v40, 5, v10
    v_lshl_add_u32 v40, v11, 2, v40
    v_mul_u32_u24 v91, 37120, v40
    v_lshl_add_u32 v91, v2, 4, v91
    v_add_u32 v92, 37120, v91
    v_add_u32 v93, 74240, v91
    v_add_u32 v94, 111360, v91
    s_mul_i32 s72, s52, 296960
    s_lshl_b32 s69, s54, 10
    s_add_u32 s72, s72, s69
    s_lshl_b32 s69, s55, 8
    s_add_u32 s72, s72, s69
    s_add_u32 s72, s72, 2097152
    s_lshl_b32 s66, s52, 5
    s_add_u32 s66, s66, 41472
    v_lshl_add_u32 v40, v40, 2, s66
    v_cmp_eq_u32 vcc, v10, v9
    s_mul_i32 s66, s52, 288
    s_add_u32 s66, s66, 41728
    v_cndmask_b32 v44, 0, v4, vcc
    v_cndmask_b32 v45, 0, v5, vcc
    v_cndmask_b32 v46, 0, v6, vcc
    v_cndmask_b32 v47, 0, v7, vcc
    v_mul_u32_u24 v41, 1152, v10
    v_lshl_add_u32 v41, v2, 4, v41
    v_lshl_add_u32 v41, v11, 3, v41
    v_add_u32 v41, s66, v41
    s_mov_b32 s70, 200000
    s_mov_b32 s76, s75
    s_waitcnt lgkmcnt(0)
    s_add_u32 s53, s53, 1
    v_and_b32 v11, 3, v1
    v_lshlrev_b32 v11, 3, v11
    s_mul_i32 s66, s53, 0x01010101
    s_xor_b32 s66, s66, 0x6b2d91c4
    v_lshrrev_b32 v11, v11, s66
    v_bfe_u32 v80, v11, 0, 1
    v_bfe_u32 v10, v11, 1, 1
    v_lshl_or_b32 v80, v10, 16, v80
    v_bfe_u32 v81, v11, 2, 1
    v_bfe_u32 v10, v11, 3, 1
    v_lshl_or_b32 v81, v10, 16, v81
    v_bfe_u32 v82, v11, 4, 1
    v_bfe_u32 v10, v11, 5, 1
    v_lshl_or_b32 v82, v10, 16, v82
    v_bfe_u32 v83, v11, 6, 1
    v_bfe_u32 v10, v11, 7, 1
    v_lshl_or_b32 v83, v10, 16, v83
    v_xor_b32 v80, 0x10000, v80
    v_xor_b32 v81, 0x10000, v81
    v_xor_b32 v82, 0x10000, v82
    v_xor_b32 v83, 0x10000, v83
    s_mov_b32 s71, 0x10000
    s_mov_b32 s73, 0x00010001
    s_setprio 2
    s_barrier
    s_barrier
    buffer_load_dwordx4 v[16:19], v12, s[20:23], s76 offen sc1
    buffer_load_dwordx4 v[20:23], v15, s[20:23], s76 offen sc1
    s_barrier
    s_waitcnt vmcnt(1)
    v_xor_b32 v14, s53, v19
    v_perm_b32 v19, v18, v17, s63
    v_perm_b32 v19, v19, v16, s64
    s_waitcnt vmcnt(0)
    v_bitop3_b32 v14, v23, s53, v14 bitop3:0xbe
    v_perm_b32 v23, v22, v21, s63
    v_perm_b32 v23, v23, v20, s64
    v_cmp_ne_u32 vcc, 0, v14
    v_pk_add_f32 v[16:17], v[16:17], v[20:21]
    v_pk_add_f32 v[18:19], v[18:19], v[22:23]
    s_cbranch_vccnz L_h1late
    s_nop 0
    v_permlane32_swap_b32 v16, v18
    v_permlane32_swap_b32 v17, v19
    v_add_f32 v16, v16, v18
    v_add_f32 v17, v17, v19
    s_nop 1
    v_permlane16_swap_b32 v16, v17
    v_add_f32 v16, v16, v17
    v_cvt_pk_bf16_f32 v16, v16, v16
    ds_write_b16 v13, v16
    s_waitcnt lgkmcnt(0)
    s_barrier
    s_barrier
    s_branch L_h1bd
L_h1retry:
    s_sub_u32 s70, s70, 1
    s_cbranch_scc1 L_h1ok
    s_cmp_lg_u32 s70, 199971
    s_cbranch_scc1 L_h1r2
    v_add_u32 v10, 36736, v8
    v_lshlrev_b32 v11, 2, v1
    v_add_u32 v11, 38784, v11
    ds_read_b128 v[28:31], v10
    ds_read_b128 v[32:35], v10 offset:1024
    ds_read_b32 v26, v11
    ds_read_b32 v27, v11 offset:256
    s_mov_b32 s66, 5242880
    s_waitcnt lgkmcnt(0)
    buffer_store_dwordx4 v[28:31], v26, s[20:23], s66 offen sc1
    buffer_store_dwordx4 v[32:35], v27, s[20:23], s66 offen sc1
L_h1r2:
    s_and_b32 s66, s70, 31
    s_cmp_eq_u32 s66, 1
    s_cselect_b32 s66, 5242880, 0
    s_add_u32 s76, s75, s66
    buffer_load_dwordx4 v[16:19], v12, s[20:23], s76 offen sc1
    buffer_load_dwordx4 v[20:23], v15, s[20:23], s76 offen sc1
    s_branch L_h1chk
L_h1late:
    s_barrier
    buffer_load_dwordx4 v[16:19], v12, s[20:23], s76 offen sc1
    buffer_load_dwordx4 v[20:23], v15, s[20:23], s76 offen sc1
    s_barrier
L_h1chk:
    s_waitcnt vmcnt(1)
    v_xor_b32 v14, s53, v19
    v_perm_b32 v19, v18, v17, s63
    v_perm_b32 v19, v19, v16, s64
    s_waitcnt vmcnt(0)
    v_bitop3_b32 v14, v23, s53, v14 bitop3:0xbe
    v_perm_b32 v23, v22, v21, s63
    v_perm_b32 v23, v23, v20, s64
    v_cmp_ne_u32 vcc, 0, v14
    v_pk_add_f32 v[16:17], v[16:17], v[20:21]
    v_pk_add_f32 v[18:19], v[18:19], v[22:23]
    s_cbranch_vccnz L_h1retry
L_h1ok:
    s_nop 0
    v_permlane32_swap_b32 v16, v18
    v_permlane32_swap_b32 v17, v19
    v_add_f32 v16, v16, v18
    v_add_f32 v17, v17, v19
    s_nop 1
    v_permlane16_swap_b32 v16, v17
    v_add_f32 v16, v16, v17
    v_cvt_pk_bf16_f32 v16, v16, v16
    ds_write_b16 v13, v16
    s_waitcnt lgkmcnt(0)
L_h1bd:
    s_barrier
    s_setprio 0
    s_barrier
    s_barrier
    buffer_load_dwordx4 v85, s[24:27], s74 offen nt lds
    s_add_u32 m0, m0, 1056
    s_add_u32 s74, s74, 8192
    buffer_load_dwordx4 v85, s[24:27], s74 offen nt lds
    s_add_u32 m0, m0, 1056
    s_add_u32 s74, s74, 8192
    buffer_load_dwordx4 v85, s[24:27], s74 offen nt lds
    s_add_u32 m0, m0, 1056
    s_add_u32 s74, s74, 8192
    buffer_load_dwordx4 v85, s[24:27], s74 offen nt lds
    s_add_u32 m0, m0, 1056
    s_add_u32 s74, s74, 8192
    buffer_load_dwordx4 v85, s[24:27], s74 offen nt lds
    s_add_u32 m0, m0, 1056
    s_add_u32 s74, s74, 8192
    s_barrier
    buffer_load_dwordx4 v85, s[24:27], s74 offen nt lds
    s_add_u32 m0, m0, 1056
    s_add_u32 s74, s74, 8192
    buffer_load_dwordx4 v85, s[24:27], s74 offen nt lds
    s_add_u32 m0, m0, 1056
    s_add_u32 s74, s74, 8192
    buffer_load_dwordx4 v85, s[24:27], s74 offen nt lds
    s_add_u32 m0, m0, 1056
    s_add_u32 s74, s74, 8192
    s_mov_b32 s70, 200000
    v_mul_u32_u24 v10, 2112, v3
    v_lshrrev_b32 v11, 2, v2
    v_lshl_add_u32 v10, v11, 8, v10
    v_and_b32 v11, 3, v1
    v_lshl_add_u32 v10, v11, 3, v10
    s_lshl_b32 s66, s3, 5
    v_add_u32 v251, s66, v10
    v_and_b32 v10, 7, v1
    v_mul_u32_u24 v248, 288, v10
    v_lshl_add_u32 v248, v3, 4, v248
    v_add_u32 v248, 41728, v248
    v_lshlrev_b32 v249, 9, v9
    v_lshl_add_u32 v249, v3, 4, v249
    v_mov_b32 v250, 41408
    s_lshl_b32 s65, s54, 13
    s_lshl_b32 s69, s55, 10
    s_add_u32 s65, s65, s69
    s_lshl_b32 s69, s3, 6
    s_add_u32 s65, s65, s69
    s_add_u32 s65, s65, 65536
    s_xor_b32 s66, s53, 0x5a5a0000
    v_mov_b32 v255, s66
    s_setprio 3
    s_waitcnt vmcnt(0)
    s_barrier
    buffer_load_dwordx4 v[48:51], v91, s[20:23], s72 offen sc1
    buffer_load_dwordx4 v[52:55], v92, s[20:23], s72 offen sc1
    buffer_load_dwordx4 v[56:59], v93, s[20:23], s72 offen sc1
    buffer_load_dwordx4 v[60:63], v94, s[20:23], s72 offen sc1
    ds_read_b64_tr_b16 v[232:233], v251 offset:0
    ds_read_b64_tr_b16 v[234:235], v251 offset:1056
    ds_read_b64_tr_b16 v[236:237], v251 offset:8448
    ds_read_b64_tr_b16 v[238:239], v251 offset:9504
    ds_read_b64_tr_b16 v[240:241], v251 offset:16896
    ds_read_b64_tr_b16 v[242:243], v251 offset:17952
    ds_read_b64_tr_b16 v[244:245], v251 offset:25344
    ds_read_b64_tr_b16 v[246:247], v251 offset:26400
    s_barrier
    ds_read_b128 v[32:35], v40
    s_waitcnt lgkmcnt(0)
    v_and_b32 v64, v32, v44
    v_and_b32 v65, v32, v45
    v_and_b32 v66, v32, v46
    v_and_b32 v67, v32, v47
    v_and_b32 v68, v33, v44
    v_and_b32 v69, v33, v45
    v_and_b32 v70, v33, v46
    v_and_b32 v71, v33, v47
    v_and_b32 v72, v34, v44
    v_and_b32 v73, v34, v45
    v_and_b32 v74, v34, v46
    v_and_b32 v75, v34, v47
    v_and_b32 v76, v35, v44
    v_and_b32 v77, v35, v45
    v_and_b32 v78, v35, v46
    v_and_b32 v79, v35, v47
L_h3chk:
    s_waitcnt vmcnt(3)
    v_xor_b32 v48, v48, v80
    v_xor_b32 v49, v49, v81
    v_xor_b32 v50, v50, v82
    v_xor_b32 v51, v51, v83
    v_or_b32 v18, v48, v49
    v_and_b32 v19, v48, v49
    v_mfma_f32_16x16x32_bf16 v[36:39], v[64:67], v[48:51], 0
    v_or3_b32 v18, v18, v50, v51
    v_bitop3_b32 v19, v19, v50, v51 bitop3:0x80
    s_waitcnt vmcnt(2)
    v_xor_b32 v52, v52, v80
    v_xor_b32 v53, v53, v81
    v_xor_b32 v54, v54, v82
    v_xor_b32 v55, v55, v83
    v_or3_b32 v18, v18, v52, v53
    v_bitop3_b32 v19, v19, v52, v53 bitop3:0x80
    v_mfma_f32_16x16x32_bf16 v[36:39], v[68:71], v[52:55], v[36:39]
    v_or3_b32 v18, v18, v54, v55
    v_bitop3_b32 v19, v19, v54, v55 bitop3:0x80
    s_waitcnt vmcnt(1)
    v_xor_b32 v56, v56, v80
    v_xor_b32 v57, v57, v81
    v_xor_b32 v58, v58, v82
    v_xor_b32 v59, v59, v83
    v_or3_b32 v18, v18, v56, v57
    v_bitop3_b32 v19, v19, v56, v57 bitop3:0x80
    v_mfma_f32_16x16x32_bf16 v[36:39], v[72:75], v[56:59], v[36:39]
    v_or3_b32 v18, v18, v58, v59
    v_bitop3_b32 v19, v19, v58, v59 bitop3:0x80
    s_waitcnt vmcnt(0)
    v_xor_b32 v60, v60, v80
    v_xor_b32 v61, v61, v81
    v_xor_b32 v62, v62, v82
    v_xor_b32 v63, v63, v83
    v_or3_b32 v18, v18, v60, v61
    v_bitop3_b32 v19, v19, v60, v61 bitop3:0x80
    v_mfma_f32_16x16x32_bf16 v[36:39], v[76:79], v[60:63], v[36:39]
    v_or3_b32 v18, v18, v62, v63
    v_bitop3_b32 v19, v19, v62, v63 bitop3:0x80
    v_bfi_b32 v18, s71, v19, v18
    v_and_b32 v18, s73, v18
    v_cmp_ne_u32 vcc, s71, v18
    s_cbranch_vccnz L_h3r
L_h3ok:
    s_nop 1
    v_cvt_pk_bf16_f32 v36, v36, v37
    v_cvt_pk_bf16_f32 v37, v38, v39
    ds_write_b64 v41, v[36:37]
L_uv:
    s_waitcnt lgkmcnt(0)
    s_barrier
    ds_read_b128 v[48:51], v248 offset:0
    ds_read_b128 v[52:55], v248 offset:64
    ds_read_b128 v[56:59], v248 offset:128
    ds_read_b128 v[60:63], v248 offset:192
    ds_read_b32 v11, v250
    s_waitcnt lgkmcnt(4)
    v_mfma_f32_16x16x32_bf16 v[20:23], v[232:235], v[48:51], 0
    s_waitcnt lgkmcnt(3)
    v_mfma_f32_16x16x32_bf16 v[20:23], v[236:239], v[52:55], v[20:23]
    s_waitcnt lgkmcnt(2)
    v_mfma_f32_16x16x32_bf16 v[20:23], v[240:243], v[56:59], v[20:23]
    s_waitcnt lgkmcnt(1)
    v_mfma_f32_16x16x32_bf16 v[20:23], v[244:247], v[60:63], v[20:23]
    s_mov_b32 s66, 0x00110011
    s_mov_b32 s67, 0x00110011
    s_nop 5
    v_add_f32_dpp v20, v20, v20 quad_perm:[1,0,3,2] row_mask:0xf bank_mask:0xf
    v_add_f32_dpp v21, v21, v21 quad_perm:[1,0,3,2] row_mask:0xf bank_mask:0xf
    v_add_f32_dpp v22, v22, v22 quad_perm:[1,0,3,2] row_mask:0xf bank_mask:0xf
    v_add_f32_dpp v23, v23, v23 quad_perm:[1,0,3,2] row_mask:0xf bank_mask:0xf
    v_add_f32_dpp v20, v20, v20 quad_perm:[2,3,0,1] row_mask:0xf bank_mask:0xf
    v_add_f32_dpp v21, v21, v21 quad_perm:[2,3,0,1] row_mask:0xf bank_mask:0xf
    v_add_f32_dpp v22, v22, v22 quad_perm:[2,3,0,1] row_mask:0xf bank_mask:0xf
    v_add_f32_dpp v23, v23, v23 quad_perm:[2,3,0,1] row_mask:0xf bank_mask:0xf
    v_perm_b32 v252, v20, v23, s60
    v_perm_b32 v253, v21, v23, s61
    v_perm_b32 v254, v22, v23, s62
    s_mov_b64 exec, s[66:67]
    buffer_store_dwordx4 v[252:255], v249, s[20:23], s65 offen
    s_waitcnt lgkmcnt(0)
    v_cmp_eq_u32 vcc, 1, v11
    s_cbranch_vccnz L_nog4
    s_add_u32 s65, s65, 5636096
    buffer_store_dwordx4 v[252:255], v249, s[20:23], s65 offen sc1
L_nog4:
    s_mov_b64 exec, -1
    s_setprio 0
    s_cmp_lt_u32 s59, 9
    s_cbranch_scc1 L_red
    s_cmp_lg_u32 s2, 247
    s_cbranch_scc1 L_fin
    s_cmp_lg_u32 s3, 0
    s_cbranch_scc1 L_fin
    v_lshlrev_b32 v12, 10, v1
    s_mov_b32 s67, 393228
    s_mov_b32 s70, 200000
L_ec:
    buffer_load_dword v13, v12, s[20:23], s67 offen sc1
    s_waitcnt vmcnt(0)
    v_cmp_ne_u32 vcc, s53, v13
    s_cbranch_vccz L_ek
    s_sub_u32 s70, s70, 1
    s_cbranch_scc0 L_ec
L_ek:
    v_mov_b32 v12, 0
    v_mov_b32 v13, s53
    s_mov_b64 exec, 1
    buffer_store_dword v13, v12, s[20:23], 0 offen sc1
    s_endpgm
L_red:
    s_mul_i32 s71, s58, 9
    s_add_u32 s71, s71, s59
    v_lshrrev_b32 v12, 2, v1
    v_mul_u32_u24 v12, 4608, v12
    v_and_b32 v14, 3, v1
    v_lshl_add_u32 v12, v14, 4, v12
    s_mul_i32 s72, s3, 73728
    s_lshl_b32 s69, s71, 6
    s_add_u32 s72, s72, s69
    s_add_u32 s72, s72, 1048576
    v_lshl_add_u32 v15, v14, 3, v3
    v_lshlrev_b32 v15, 1, v15
    s_lshl_b32 s66, s3, 2
    s_add_u32 s66, s66, 39296
    v_lshl_add_u32 v13, v1, 5, s66
    s_mov_b32 s70, 200000
    s_cmp_lg_u32 s3, 2
    s_cbranch_scc1 L_g5_k
    s_cmp_lt_u32 s71, 64
    s_cbranch_scc0 L_rt
    s_lshr_b32 s66, s71, 4
    s_and_b32 s67, s71, 3
    s_lshl_b32 s73, s66, 7
    s_lshl_b32 s69, s67, 5
    s_add_u32 s73, s73, s69
    s_bfe_u32 s67, s71, 0x20002
    s_branch L_rd
L_rt:
    s_and_b32 s66, s71, 1
    s_lshl_b32 s73, s66, 5
    s_add_u32 s73, s73, 512
    s_bfe_u32 s67, s71, 0x20001
L_rd:
    s_lshr_b32 s66, s67, 1
    s_and_b32 s67, s67, 1
    s_lshl_b32 s73, s73, 1
    s_lshl_b32 s69, s66, 3
    s_add_u32 s73, s73, s69
    s_mul_i32 s74, s67, 1152
    s_add_u32 s74, s74, s73
    buffer_load_ushort v28, v15, s[4:7], s74 offen
    buffer_load_ushort v29, v15, s[44:47], s73 offen
    v_and_b32 v16, 12, v1
    v_cmp_eq_u32 s[56:57], 0, v16
    v_lshlrev_b32 v17, 5, v1
    v_add_u32 v17, 39296, v17
    s_waitcnt vmcnt(0)
    v_lshlrev_b32 v28, 16, v28
    v_lshlrev_b32 v29, 16, v29
    v_add_f32 v28, v28, v29
L_rgo:
    s_lshl_b32 s67, s58, 10
    s_add_u32 s67, s67, 983040
    v_lshlrev_b32 v25, 6, v2
    s_mov_b32 s66, 36
L_g5:
    buffer_load_dwordx2 v[26:27], v25, s[20:23], s67 offen sc1
    s_sub_u32 s66, s66, 1
    s_cbranch_scc1 L_g5_r
    s_waitcnt vmcnt(0)
    v_cmp_ne_u32 vcc, s53, v26
    s_cbranch_vccnz L_g5
L_g5_k:
    s_barrier
L_h5chk:
    buffer_load_dwordx4 v[32:35], v12, s[20:23], s72 offen sc1
    s_sub_u32 s70, s70, 1
    s_cbranch_scc1 L_h5r
    s_waitcnt vmcnt(0)
    v_cmp_ne_u32 vcc, s53, v35
    v_perm_b32 v35, v34, v33, s63
    v_perm_b32 v35, v35, v32, s64
    s_cbranch_vccnz L_h5chk
L_h5ok:
    v_permlane32_swap_b32 v32, v34
    v_permlane32_swap_b32 v33, v35
    v_add_f32 v32, v32, v34
    v_add_f32 v33, v33, v35
    s_nop 1
    v_permlane16_swap_b32 v32, v33
    v_add_f32 v32, v32, v33
    s_nop 1
    v_add_f32_dpp v32, v32, v32 row_ror:8 row_mask:0xf bank_mask:0xf
    s_nop 1
    v_add_f32_dpp v32, v32, v32 row_ror:4 row_mask:0xf bank_mask:0xf
    s_cmp_lg_u32 s3, 2
    ds_write_b32 v13, v32
    s_waitcnt lgkmcnt(0)
    s_barrier
    s_cbranch_scc1 L_fin
    ds_read_b128 v[32:35], v17
    ds_read_b128 v[36:39], v17 offset:16
    s_mov_b64 exec, s[56:57]
    s_waitcnt lgkmcnt(0)
    v_pk_add_f32 v[32:33], v[32:33], v[36:37]
    v_pk_add_f32 v[34:35], v[34:35], v[38:39]
    v_add_f32 v32, v32, v33
    v_add_f32 v34, v34, v35
    v_add_f32 v32, v32, v28
    v_add_f32 v32, v32, v34
    v_cvt_pk_bf16_f32 v32, v32, v32
    buffer_store_short v32, v15, s[48:51], s74 offen
    s_branch L_fin
L_PV:
    s_waitcnt lgkmcnt(0)
    s_load_dword s53, s[20:21], 0
    s_load_dwordx2 s[28:29], s[0:1], 40
    s_load_dwordx2 s[40:41], s[0:1], 72
    s_load_dwordx2 s[36:37], s[0:1], 64
    s_mov_b32 s22, 268435456
    s_mov_b32 s23, 0x20000
    s_mov_b32 s30, 4718592
    s_mov_b32 s31, 0x20000
    s_mov_b32 s42, 5308416
    s_mov_b32 s43, 0x20000
    s_mov_b32 s38, 9216
    s_mov_b32 s39, 0x20000
    s_lshl_b32 s65, s59, 3
    s_add_u32 s65, s65, s58
    s_and_b32 s52, s3, 3
    s_and_b32 s69, s59, 3
    s_lshl_b32 s54, s58, 2
    s_add_u32 s54, s54, s69
    s_lshr_b32 s55, s59, 2
    v_and_b32 v2, 15, v1
    v_lshrrev_b32 v3, 4, v1
    v_lshlrev_b32 v8, 4, v1
    v_bfe_u32 v9, v1, 2, 1
    v_and_b32 v10, 3, v1
    v_lshlrev_b32 v10, 4, v10
    v_mov_b32 v4, 0xffff
    v_mov_b32 v5, 0
    v_lshlrev_b64 v[4:5], v10, v[4:5]
    v_bfe_i32 v10, v1, 3, 1
    v_and_b32 v6, v10, v4
    v_and_b32 v7, v10, v5
    v_xor_b32 v4, v4, v6
    v_xor_b32 v5, v5, v7
    s_mov_b32 s60, 0x07060501
    s_mov_b32 s61, 0x07060502
    s_mov_b32 s62, 0x07060503
    s_mov_b32 s63, 0x04000c0c
    s_mov_b32 s64, 0x0706000c
    s_mov_b32 s100, 0x01000100
    s_mov_b32 s101, 0x03020302
    s_lshr_b32 s66, s59, 1
    s_lshl_b32 s57, s58, 3
    s_add_u32 s57, s57, s66
    s_and_b32 s56, s59, 1
    s_lshr_b32 s67, s57, 5
    s_lshl_b32 s72, s67, 15
    s_lshl_b32 s69, s56, 14
    s_add_u32 s72, s72, s69
    s_lshl_b32 s69, s3, 11
    s_add_u32 s72, s72, s69
    s_add_u32 s72, s72, 327680
    s_mul_i32 s66, s3, 2112
    s_add_u32 s66, s66, 135168
    v_add_u32 v12, s66, v8
    s_mov_b32 s70, 200000
    s_mul_i32 s75, s57, 37120
    s_lshl_b32 s69, s56, 14
    s_add_u32 s75, s75, s69
    s_lshl_b32 s69, s52, 8
    s_add_u32 s75, s75, s69
    s_add_u32 s75, s75, 2097152
    v_lshrrev_b32 v80, 2, v1
    v_mul_u32_u24 v80, 1056, v80
    v_and_b32 v10, 3, v1
    v_lshl_add_u32 v80, v10, 3, v80
    s_lshl_b32 s67, s52, 8
    v_add_u32 v80, s67, v80
    v_add_u32 v81, 67584, v80
    v_add_u32 v82, 153344, v8
    v_lshlrev_b32 v83, 12, v3
    v_lshl_add_u32 v83, v2, 3, v83
    v_mov_b32 v10, 157440
    v_mov_b32 v11, 0
    ds_write_b32 v10, v11
    s_waitcnt lgkmcnt(0)
    s_add_u32 s53, s53, 1
    v_and_b32 v11, 3, v1
    v_lshlrev_b32 v11, 3, v11
    s_mul_i32 s66, s53, 0x01010101
    s_xor_b32 s66, s66, 0x6b2d91c4
    v_lshrrev_b32 v11, v11, s66
    v_bfe_u32 v232, v11, 0, 1
    v_bfe_u32 v10, v11, 1, 1
    v_lshl_or_b32 v232, v10, 16, v232
    v_bfe_u32 v233, v11, 2, 1
    v_bfe_u32 v10, v11, 3, 1
    v_lshl_or_b32 v233, v10, 16, v233
    v_bfe_u32 v234, v11, 4, 1
    v_bfe_u32 v10, v11, 5, 1
    v_lshl_or_b32 v234, v10, 16, v234
    v_bfe_u32 v235, v11, 6, 1
    v_bfe_u32 v10, v11, 7, 1
    v_lshl_or_b32 v235, v10, 16, v235
    s_mov_b32 s73, 0x00010001
    v_and_b32 v11, 7, v1
    v_lshlrev_b32 v11, 2, v11
    s_mul_i32 s66, s53, 0x01010101
    s_xor_b32 s66, s66, 0x6b2d91c4
    v_lshrrev_b32 v11, v11, s66
    v_bfe_u32 v236, v11, 0, 1
    v_bfe_u32 v10, v11, 1, 1
    v_lshl_or_b32 v236, v10, 16, v236
    v_bfe_u32 v237, v11, 2, 1
    v_bfe_u32 v10, v11, 3, 1
    v_lshl_or_b32 v237, v10, 16, v237
    s_mov_b32 s76, 0xfffefffe
    s_barrier
    s_lshl_b32 s66, s57, 10
    s_lshl_b32 s69, s56, 9
    s_add_u32 s66, s66, s69
    s_lshl_b32 s69, s52, 7
    s_add_u32 s66, s66, s69
    s_add_u32 s66, s66, 393216
    v_lshlrev_b32 v91, 7, v1
    s_bfm_b64 exec, 1, 0
    buffer_load_dword v91, v91, s[20:23], s66 offen sc1
    s_mov_b64 exec, -1
    s_lshl_b32 s67, s58, 10
    s_add_u32 s67, s67, 999424
    v_lshlrev_b32 v25, 6, v2
    s_cmp_lg_u32 s52, 0
    s_cbranch_scc1 L_nw2
    buffer_load_dword v26, v25, s[20:23], s67 offen sc1
L_nw2:
    s_barrier
    ds_read_b64_tr_b16 v[96:97], v80 offset:0
    ds_read_b64_tr_b16 v[112:113], v80 offset:32
    ds_read_b64_tr_b16 v[128:129], v80 offset:64
    ds_read_b64_tr_b16 v[144:145], v80 offset:96
    ds_read_b64_tr_b16 v[160:161], v80 offset:128
    ds_read_b64_tr_b16 v[176:177], v80 offset:160
    ds_read_b64_tr_b16 v[192:193], v80 offset:192
    ds_read_b64_tr_b16 v[208:209], v80 offset:224
    ds_read_b64_tr_b16 v[100:101], v80 offset:33792
    ds_read_b64_tr_b16 v[116:117], v80 offset:33824
    ds_read_b64_tr_b16 v[132:133], v80 offset:33856
    ds_read_b64_tr_b16 v[148:149], v80 offset:33888
    ds_read_b64_tr_b16 v[164:165], v80 offset:33920
    ds_read_b64_tr_b16 v[180:181], v80 offset:33952
    ds_read_b64_tr_b16 v[196:197], v80 offset:33984
    ds_read_b64_tr_b16 v[212:213], v80 offset:34016
    ds_read_b64_tr_b16 v[104:105], v81 offset:0
    ds_read_b64_tr_b16 v[120:121], v81 offset:32
    ds_read_b64_tr_b16 v[136:137], v81 offset:64
    ds_read_b64_tr_b16 v[152:153], v81 offset:96
    ds_read_b64_tr_b16 v[168:169], v81 offset:128
    ds_read_b64_tr_b16 v[184:185], v81 offset:160
    ds_read_b64_tr_b16 v[200:201], v81 offset:192
    ds_read_b64_tr_b16 v[216:217], v81 offset:224
    ds_read_b64_tr_b16 v[108:109], v81 offset:33792
    ds_read_b64_tr_b16 v[124:125], v81 offset:33824
    ds_read_b64_tr_b16 v[140:141], v81 offset:33856
    ds_read_b64_tr_b16 v[156:157], v81 offset:33888
    ds_read_b64_tr_b16 v[172:173], v81 offset:33920
    ds_read_b64_tr_b16 v[188:189], v81 offset:33952
    ds_read_b64_tr_b16 v[204:205], v81 offset:33984
    ds_read_b64_tr_b16 v[220:221], v81 offset:34016
    s_barrier
    s_cmp_lg_u32 s52, 0
    s_cbranch_scc1 L_af_k
    s_mov_b32 s66, 12
L_af:
    buffer_load_dwordx2 v[26:27], v25, s[20:23], s67 offen sc1
    s_sub_u32 s66, s66, 1
    s_cbranch_scc1 L_af_r
    s_waitcnt vmcnt(0)
    v_cmp_ne_u32 vcc, s53, v26
    s_cbranch_vccnz L_af
L_af_k:
    s_barrier
    buffer_load_dwordx4 v[16:19], v8, s[20:23], s72 offen sc1
    buffer_load_dwordx4 v[20:23], v8, s[20:23], s72 offen offset:1024 sc1
    s_barrier
    ds_read_b64_tr_b16 v[98:99], v80 offset:16896
    ds_read_b64_tr_b16 v[114:115], v80 offset:16928
    ds_read_b64_tr_b16 v[130:131], v80 offset:16960
    ds_read_b64_tr_b16 v[146:147], v80 offset:16992
    ds_read_b64_tr_b16 v[162:163], v80 offset:17024
    ds_read_b64_tr_b16 v[178:179], v80 offset:17056
    ds_read_b64_tr_b16 v[194:195], v80 offset:17088
    ds_read_b64_tr_b16 v[210:211], v80 offset:17120
    ds_read_b64_tr_b16 v[102:103], v80 offset:50688
    ds_read_b64_tr_b16 v[118:119], v80 offset:50720
    ds_read_b64_tr_b16 v[134:135], v80 offset:50752
    ds_read_b64_tr_b16 v[150:151], v80 offset:50784
    ds_read_b64_tr_b16 v[166:167], v80 offset:50816
    ds_read_b64_tr_b16 v[182:183], v80 offset:50848
    ds_read_b64_tr_b16 v[198:199], v80 offset:50880
    ds_read_b64_tr_b16 v[214:215], v80 offset:50912
    ds_read_b64_tr_b16 v[106:107], v81 offset:16896
    ds_read_b64_tr_b16 v[122:123], v81 offset:16928
    ds_read_b64_tr_b16 v[138:139], v81 offset:16960
    ds_read_b64_tr_b16 v[154:155], v81 offset:16992
    ds_read_b64_tr_b16 v[170:171], v81 offset:17024
    ds_read_b64_tr_b16 v[186:187], v81 offset:17056
    ds_read_b64_tr_b16 v[202:203], v81 offset:17088
    ds_read_b64_tr_b16 v[218:219], v81 offset:17120
    ds_read_b64_tr_b16 v[110:111], v81 offset:50688
    ds_read_b64_tr_b16 v[126:127], v81 offset:50720
    ds_read_b64_tr_b16 v[142:143], v81 offset:50752
    ds_read_b64_tr_b16 v[158:159], v81 offset:50784
    ds_read_b64_tr_b16 v[174:175], v81 offset:50816
    ds_read_b64_tr_b16 v[190:191], v81 offset:50848
    ds_read_b64_tr_b16 v[206:207], v81 offset:50880
    ds_read_b64_tr_b16 v[222:223], v81 offset:50912
L_h2chkp:
    s_waitcnt vmcnt(1)
    v_xor_b32 v16, v16, v232
    v_xor_b32 v17, v17, v233
    v_xor_b32 v18, v18, v234
    v_xor_b32 v19, v19, v235
    ds_write_b128 v12, v[16:19]
    v_or3_b32 v13, v16, v17, v18
    s_waitcnt vmcnt(0)
    v_xor_b32 v20, v20, v232
    v_xor_b32 v21, v21, v233
    v_xor_b32 v22, v22, v234
    v_xor_b32 v23, v23, v235
    ds_write_b128 v12, v[20:23] offset:1056
    v_or3_b32 v13, v13, v19, v20
    v_or3_b32 v13, v13, v21, v22
    v_bitop3_b32 v13, v13, v23, s73 bitop3:0xa8
    v_cmp_ne_u32 vcc, 0, v13
    s_cbranch_vccnz L_h2rp
L_h2okp:
    s_waitcnt lgkmcnt(0)
    s_barrier
    s_barrier
    s_setprio 3
    s_barrier
    ds_read_b128 v[16:19], v82 offset:0
    ds_read_b128 v[20:23], v82 offset:1024
    ds_read_b128 v[24:27], v82 offset:2048
    ds_read_b128 v[28:31], v82 offset:3072
    s_waitcnt lgkmcnt(3)
    v_mfma_f32_16x16x32_bf16 v[32:35], v[16:19], v[96:99], 0
    v_mfma_f32_16x16x32_bf16 v[36:39], v[16:19], v[112:115], 0
    s_waitcnt lgkmcnt(2)
    v_mfma_f32_16x16x32_bf16 v[32:35], v[20:23], v[100:103], v[32:35]
    v_mfma_f32_16x16x32_bf16 v[36:39], v[20:23], v[116:119], v[36:39]
    s_waitcnt lgkmcnt(1)
    v_mfma_f32_16x16x32_bf16 v[32:35], v[24:27], v[104:107], v[32:35]
    v_mfma_f32_16x16x32_bf16 v[36:39], v[24:27], v[120:123], v[36:39]
    s_waitcnt lgkmcnt(0)
    v_mfma_f32_16x16x32_bf16 v[32:35], v[28:31], v[108:111], v[32:35]
    v_mfma_f32_16x16x32_bf16 v[36:39], v[28:31], v[124:127], v[36:39]
    v_mfma_f32_16x16x32_bf16 v[40:43], v[16:19], v[128:131], 0
    v_mfma_f32_16x16x32_bf16 v[44:47], v[16:19], v[144:147], 0
    v_mfma_f32_16x16x32_bf16 v[40:43], v[20:23], v[132:135], v[40:43]
    v_mfma_f32_16x16x32_bf16 v[44:47], v[20:23], v[148:151], v[44:47]
    v_mfma_f32_16x16x32_bf16 v[40:43], v[24:27], v[136:139], v[40:43]
    v_mfma_f32_16x16x32_bf16 v[44:47], v[24:27], v[152:155], v[44:47]
    v_mfma_f32_16x16x32_bf16 v[40:43], v[28:31], v[140:143], v[40:43]
    v_mfma_f32_16x16x32_bf16 v[44:47], v[28:31], v[156:159], v[44:47]
    v_cvt_pk_bf16_f32 v64, v32, v36
    v_and_or_b32 v64, v64, s76, v236
    v_mfma_f32_16x16x32_bf16 v[48:51], v[16:19], v[160:163], 0
    v_cvt_pk_bf16_f32 v68, v33, v37
    v_and_or_b32 v68, v68, s76, v236
    v_mfma_f32_16x16x32_bf16 v[52:55], v[16:19], v[176:179], 0
    v_cvt_pk_bf16_f32 v72, v34, v38
    v_and_or_b32 v72, v72, s76, v236
    v_mfma_f32_16x16x32_bf16 v[48:51], v[20:23], v[164:167], v[48:51]
    v_cvt_pk_bf16_f32 v76, v35, v39
    v_and_or_b32 v76, v76, s76, v236
    v_mfma_f32_16x16x32_bf16 v[52:55], v[20:23], v[180:183], v[52:55]
    v_cvt_pk_bf16_f32 v65, v40, v44
    v_and_or_b32 v65, v65, s76, v237
    v_mfma_f32_16x16x32_bf16 v[48:51], v[24:27], v[168:171], v[48:51]
    v_cvt_pk_bf16_f32 v69, v41, v45
    v_and_or_b32 v69, v69, s76, v237
    v_mfma_f32_16x16x32_bf16 v[52:55], v[24:27], v[184:187], v[52:55]
    v_cvt_pk_bf16_f32 v73, v42, v46
    v_and_or_b32 v73, v73, s76, v237
    v_mfma_f32_16x16x32_bf16 v[48:51], v[28:31], v[172:175], v[48:51]
    v_cvt_pk_bf16_f32 v77, v43, v47
    v_and_or_b32 v77, v77, s76, v237
    v_mfma_f32_16x16x32_bf16 v[52:55], v[28:31], v[188:191], v[52:55]
    buffer_store_dwordx2 v[64:65], v83, s[20:23], s75 offen offset:0 sc1
    v_mfma_f32_16x16x32_bf16 v[56:59], v[16:19], v[192:195], 0
    buffer_store_dwordx2 v[68:69], v83, s[20:23], s75 offen offset:1024 sc1
    v_mfma_f32_16x16x32_bf16 v[60:63], v[16:19], v[208:211], 0
    buffer_store_dwordx2 v[72:73], v83, s[20:23], s75 offen offset:2048 sc1
    v_mfma_f32_16x16x32_bf16 v[56:59], v[20:23], v[196:199], v[56:59]
    buffer_store_dwordx2 v[76:77], v83, s[20:23], s75 offen offset:3072 sc1
    v_mfma_f32_16x16x32_bf16 v[60:63], v[20:23], v[212:215], v[60:63]
    v_mfma_f32_16x16x32_bf16 v[56:59], v[24:27], v[200:203], v[56:59]
    v_cvt_pk_bf16_f32 v66, v48, v52
    v_and_or_b32 v66, v66, s76, v236
    v_mfma_f32_16x16x32_bf16 v[60:63], v[24:27], v[216:219], v[60:63]
    v_cvt_pk_bf16_f32 v70, v49, v53
    v_and_or_b32 v70, v70, s76, v236
    v_mfma_f32_16x16x32_bf16 v[56:59], v[28:31], v[204:207], v[56:59]
    v_cvt_pk_bf16_f32 v74, v50, v54
    v_and_or_b32 v74, v74, s76, v236
    v_mfma_f32_16x16x32_bf16 v[60:63], v[28:31], v[220:223], v[60:63]
    v_cvt_pk_bf16_f32 v78, v51, v55
    v_and_or_b32 v78, v78, s76, v236
    s_nop 5
    v_cvt_pk_bf16_f32 v67, v56, v60
    v_and_or_b32 v67, v67, s76, v237
    buffer_store_dwordx2 v[66:67], v83, s[20:23], s75 offen offset:128 sc1
    v_cvt_pk_bf16_f32 v71, v57, v61
    v_and_or_b32 v71, v71, s76, v237
    buffer_store_dwordx2 v[70:71], v83, s[20:23], s75 offen offset:1152 sc1
    v_cvt_pk_bf16_f32 v75, v58, v62
    v_and_or_b32 v75, v75, s76, v237
    buffer_store_dwordx2 v[74:75], v83, s[20:23], s75 offen offset:2176 sc1
    v_cvt_pk_bf16_f32 v79, v59, v63
    v_and_or_b32 v79, v79, s76, v237
    buffer_store_dwordx2 v[78:79], v83, s[20:23], s75 offen offset:3200 sc1
    s_barrier
    s_setprio 1
    s_and_b32 s56, s58, 1
    s_lshr_b32 s66, s58, 1
    s_mul_i32 s68, s66, 9
    s_lshl_b32 s69, s56, 2
    s_add_u32 s68, s68, s69
    s_lshl_b32 s57, s68, 7
    s_lshl_b32 s69, s59, 5
    s_add_u32 s57, s57, s69
    s_lshr_b32 s66, s59, 1
    s_and_b32 s67, s59, 1
    s_lshl_b32 s77, s68, 7
    s_lshl_b32 s69, s66, 5
    s_add_u32 s77, s77, s69
    s_lshl_b32 s69, s67, 2
    s_add_u32 s77, s77, s69
    s_add_u32 s77, s77, 1024
    s_cmp_lt_u32 s59, 8
    s_cselect_b32 s69, 1, 0
    s_andn2_b32 s56, s69, s56
    s_cmp_eq_u32 s52, 1
    s_cbranch_scc1 L_tail
    s_cmp_lg_u32 s52, 2
    s_cbranch_scc1 L_fin
    s_mul_i32 s71, s68, 6144
    s_lshl_b32 s69, s66, 6
    s_add_u32 s71, s71, s69
    s_lshl_b32 s69, s67, 9
    s_add_u32 s71, s71, s69
    s_add_u32 s71, s71, 6012928
    s_and_b32 s67, s59, 3
    s_mul_i32 s75, s68, 6144
    s_mul_i32 s69, s55, 6144
    s_add_u32 s75, s75, s69
    s_lshl_b32 s69, s67, 6
    s_add_u32 s75, s75, s69
    s_add_u32 s75, s75, 720896
    v_and_b32 v10, 3, v1
    v_lshrrev_b32 v11, 3, v1
    v_cmp_gt_u32 vcc, 6, v11
    v_min_u32 v11, 5, v11
    v_lshlrev_b32 v87, 10, v11
    v_cndmask_b32 v88, 0, -1, vcc
    v_lshl_add_u32 v87, v9, 8, v87
    v_lshl_add_u32 v87, v10, 4, v87
    v_lshl_add_u32 v89, v10, 3, v3
    v_lshlrev_b32 v89, 1, v89
    s_lshl_b32 s68, s57, 1
    buffer_load_ushort v12, v89, s[36:39], s68 offen
    buffer_load_ushort v13, v89, s[36:39], s68 offen offset:8
    s_lshl_b32 s68, s77, 1
    buffer_load_ushort v14, v89, s[36:39], s68 offen
    v_mov_b32 v92, 157440
    v_lshlrev_b32 v93, 2, v1
    v_add_u32 v93, 157504, v93
    s_mov_b32 s70, 200000
L_hfchk:
    s_and_b32 s66, s70, 31
    s_cmp_eq_u32 s66, 1
    s_cselect_b32 s66, 5242880, 0
    s_add_u32 s76, s75, s66
    s_cmp_eq_u32 s56, 0
    s_cselect_b32 s68, s76, s71
    buffer_load_dwordx4 v[32:35], v87, s[20:23], s76 offen sc1
    buffer_load_dwordx4 v[36:39], v87, s[20:23], s76 offen offset:512 sc1
    buffer_load_dwordx4 v[40:43], v87, s[20:23], s68 offen sc1
    s_waitcnt vmcnt(0)
    v_xor_b32 v16, s53, v35
    v_bitop3_b32 v16, v39, s53, v16 bitop3:0xbe
    v_bitop3_b32 v16, v43, s53, v16 bitop3:0xbe
    v_cmp_ne_u32 vcc, 0, v16
    s_cbranch_vccz L_hfok
    s_sub_u32 s70, s70, 1
    s_cbranch_scc0 L_hfchk
L_hfok:
    v_perm_b32 v35, v34, v33, s63
    v_perm_b32 v35, v35, v32, s64
    v_and_b32 v32, v88, v32
    v_and_b32 v33, v88, v33
    v_and_b32 v34, v88, v34
    v_and_b32 v35, v88, v35
    s_nop 0
    v_permlane32_swap_b32 v32, v34
    v_permlane32_swap_b32 v33, v35
    v_add_f32 v32, v32, v34
    v_add_f32 v33, v33, v35
    s_nop 1
    v_permlane16_swap_b32 v32, v33
    v_add_f32 v32, v32, v33
    s_nop 1
    v_add_f32_dpp v32, v32, v32 row_ror:8 row_mask:0xf bank_mask:0xf
    v_lshlrev_b32 v12, 16, v12
    v_cvt_pk_bf16_f32 v32, v32, v32
    v_and_b32 v32, 0xffff0000, v32
    v_add_f32 v32, v32, v12
    v_cvt_pk_bf16_f32 v32, v32, v32
    v_and_b32 v32, 0xffff0000, v32
    v_cmp_lt_f32 vcc, 0, v32
    v_mul_f32 v32, v32, v32
    v_cvt_pk_bf16_f32 v32, v32, v32
    v_cndmask_b32 v32, 0, v32, vcc
    ds_write_b32 v93, v32 offset:0
    v_perm_b32 v39, v38, v37, s63
    v_perm_b32 v39, v39, v36, s64
    v_and_b32 v36, v88, v36
    v_and_b32 v37, v88, v37
    v_and_b32 v38, v88, v38
    v_and_b32 v39, v88, v39
    s_nop 0
    v_permlane32_swap_b32 v36, v38
    v_permlane32_swap_b32 v37, v39
    v_add_f32 v36, v36, v38
    v_add_f32 v37, v37, v39
    s_nop 1
    v_permlane16_swap_b32 v36, v37
    v_add_f32 v36, v36, v37
    s_nop 1
    v_add_f32_dpp v36, v36, v36 row_ror:8 row_mask:0xf bank_mask:0xf
    v_lshlrev_b32 v13, 16, v13
    v_cvt_pk_bf16_f32 v36, v36, v36
    v_and_b32 v36, 0xffff0000, v36
    v_add_f32 v36, v36, v13
    v_cvt_pk_bf16_f32 v36, v36, v36
    v_and_b32 v36, 0xffff0000, v36
    v_cmp_lt_f32 vcc, 0, v36
    v_mul_f32 v36, v36, v36
    v_cvt_pk_bf16_f32 v36, v36, v36
    v_cndmask_b32 v36, 0, v36, vcc
    ds_write_b32 v93, v36 offset:256
    v_perm_b32 v43, v42, v41, s63
    v_perm_b32 v43, v43, v40, s64
    v_and_b32 v40, v88, v40
    v_and_b32 v41, v88, v41
    v_and_b32 v42, v88, v42
    v_and_b32 v43, v88, v43
    s_nop 0
    v_permlane32_swap_b32 v40, v42
    v_permlane32_swap_b32 v41, v43
    v_add_f32 v40, v40, v42
    v_add_f32 v41, v41, v43
    s_nop 1
    v_permlane16_swap_b32 v40, v41
    v_add_f32 v40, v40, v41
    s_nop 1
    v_add_f32_dpp v40, v40, v40 row_ror:8 row_mask:0xf bank_mask:0xf
    v_lshlrev_b32 v14, 16, v14
    v_cvt_pk_bf16_f32 v40, v40, v40
    v_and_b32 v40, 0xffff0000, v40
    v_add_f32 v40, v40, v14
    v_cvt_pk_bf16_f32 v40, v40, v40
    v_and_b32 v40, 0xffff0000, v40
    v_cmp_lt_f32 vcc, 0, v40
    v_mul_f32 v40, v40, v40
    v_cvt_pk_bf16_f32 v40, v40, v40
    v_cndmask_b32 v40, 0, v40, vcc
    ds_write_b32 v93, v40 offset:512
    ds_write_b32 v92, v92
    s_branch L_fin
L_tail:
    v_mul_u32_u24 v85, 1152, v3
    v_lshl_add_u32 v85, v2, 4, v85
    v_lshrrev_b32 v11, 3, v2
    v_mul_u32_u24 v90, 4480, v11
    v_add_u32 v90, v90, v85
    v_mul_u32_u24 v89, 18304, v11
    v_add_u32 v89, v89, v85
    v_cmp_gt_u32 vcc, 8, v2
    v_mov_b32 v11, 1073741824
    v_lshlrev_b32 v91, 7, v3
    v_lshl_add_u32 v91, v2, 4, v91
    v_cndmask_b32 v85, v11, v85, vcc
    v_cndmask_b32 v91, v11, v91, vcc
    s_mul_i32 s74, s57, 1152
    s_add_u32 s74, s74, 1024
    buffer_load_dwordx4 v[96:99], v90, s[40:43], s74 offen nt
    s_add_u32 s74, s74, 9216
    buffer_load_dwordx4 v[100:103], v90, s[40:43], s74 offen nt
    s_add_u32 s74, s74, 9216
    buffer_load_dwordx4 v[104:107], v90, s[40:43], s74 offen nt
    s_add_u32 s74, s74, 9216
    buffer_load_dwordx4 v[108:111], v90, s[40:43], s74 offen nt
    s_add_u32 s74, s74, 9216
    s_mul_i32 s74, s54, 147456
    s_mul_i32 s69, s55, 36864
    s_add_u32 s74, s74, s69
    s_add_u32 s74, s74, 1024
    buffer_load_dwordx4 v[128:131], v89, s[28:31], s74 offen nt
    s_add_u32 s74, s74, 4608
    buffer_load_dwordx4 v[132:135], v89, s[28:31], s74 offen nt
    s_add_u32 s74, s74, 4608
    buffer_load_dwordx4 v[136:139], v89, s[28:31], s74 offen nt
    s_add_u32 s74, s74, 4608
    buffer_load_dwordx4 v[140:143], v89, s[28:31], s74 offen nt
    s_add_u32 s74, s74, 4608
    s_cmp_eq_u32 s56, 0
    s_cbranch_scc1 L_no3b
    s_mul_i32 s74, s77, 1152
    s_add_u32 s74, s74, 1024
    buffer_load_dwordx4 v[112:115], v85, s[40:43], s74 offen nt
    s_add_u32 s74, s74, 9216
    buffer_load_dwordx4 v[116:119], v85, s[40:43], s74 offen nt
    s_add_u32 s74, s74, 9216
    buffer_load_dwordx4 v[120:123], v85, s[40:43], s74 offen nt
    s_add_u32 s74, s74, 9216
    buffer_load_dwordx4 v[124:127], v85, s[40:43], s74 offen nt
    s_add_u32 s74, s74, 9216
L_no3b:
    v_and_b32 v10, 3, v1
    v_bfe_u32 v11, v1, 3, 1
    v_lshl_add_u32 v10, v11, 2, v10
    v_lshlrev_b32 v86, 10, v3
    v_lshl_add_u32 v86, v9, 9, v86
    v_lshl_add_u32 v86, v10, 4, v86
    s_lshl_b32 s72, s54, 13
    s_lshl_b32 s69, s55, 7
    s_add_u32 s72, s72, s69
    s_add_u32 s72, s72, 65536
    v_mov_b32 v92, 157440
    v_lshlrev_b32 v93, 2, v1
    v_add_u32 v93, 157504, v93
    v_mov_b32 v47, s53
    s_xor_b32 s53, s53, 0x5a5a0000
    s_mov_b32 s71, s72
    s_mov_b32 s70, 200000
    s_mul_i32 s75, s65, 4608
    s_add_u32 s75, s75, 1052672
L_hwb:
    s_sleep 1
    ds_read_b32 v11, v92
    s_waitcnt lgkmcnt(0)
    v_cmp_eq_u32 vcc, 0, v11
    s_cbranch_vccnz L_hwb
    ds_read_b32 v12, v93 offset:0
    ds_read_b32 v13, v93 offset:256
    ds_read_b32 v14, v93 offset:512
    s_waitcnt vmcnt(0) lgkmcnt(0)
    v_and_b32_dpp v64, v12, v4 quad_perm:[0,0,0,0] row_mask:0xf bank_mask:0xf
    v_and_b32_dpp v65, v12, v5 quad_perm:[0,0,0,0] row_mask:0xf bank_mask:0xf
    v_and_b32_dpp v66, v12, v6 quad_perm:[0,0,0,0] row_mask:0xf bank_mask:0xf
    v_and_b32_dpp v67, v12, v7 quad_perm:[0,0,0,0] row_mask:0xf bank_mask:0xf
    v_and_b32_dpp v68, v12, v4 quad_perm:[1,1,1,1] row_mask:0xf bank_mask:0xf
    v_and_b32_dpp v69, v12, v5 quad_perm:[1,1,1,1] row_mask:0xf bank_mask:0xf
    v_and_b32_dpp v70, v12, v6 quad_perm:[1,1,1,1] row_mask:0xf bank_mask:0xf
    v_and_b32_dpp v71, v12, v7 quad_perm:[1,1,1,1] row_mask:0xf bank_mask:0xf
    v_mfma_f32_16x16x32_bf16 v[24:27], v[64:67], v[96:99], 0
    v_and_b32_dpp v72, v12, v4 quad_perm:[2,2,2,2] row_mask:0xf bank_mask:0xf
    v_and_b32_dpp v73, v12, v5 quad_perm:[2,2,2,2] row_mask:0xf bank_mask:0xf
    v_and_b32_dpp v74, v12, v6 quad_perm:[2,2,2,2] row_mask:0xf bank_mask:0xf
    v_and_b32_dpp v75, v12, v7 quad_perm:[2,2,2,2] row_mask:0xf bank_mask:0xf
    v_mfma_f32_16x16x32_bf16 v[24:27], v[68:71], v[100:103], v[24:27]
    v_and_b32_dpp v76, v12, v4 quad_perm:[3,3,3,3] row_mask:0xf bank_mask:0xf
    v_and_b32_dpp v77, v12, v5 quad_perm:[3,3,3,3] row_mask:0xf bank_mask:0xf
    v_and_b32_dpp v78, v12, v6 quad_perm:[3,3,3,3] row_mask:0xf bank_mask:0xf
    v_and_b32_dpp v79, v12, v7 quad_perm:[3,3,3,3] row_mask:0xf bank_mask:0xf
    v_mfma_f32_16x16x32_bf16 v[24:27], v[72:75], v[104:107], v[24:27]
    v_and_b32_dpp v64, v13, v4 quad_perm:[0,0,0,0] row_mask:0xf bank_mask:0xf
    v_and_b32_dpp v65, v13, v5 quad_perm:[0,0,0,0] row_mask:0xf bank_mask:0xf
    v_and_b32_dpp v66, v13, v6 quad_perm:[0,0,0,0] row_mask:0xf bank_mask:0xf
    v_and_b32_dpp v67, v13, v7 quad_perm:[0,0,0,0] row_mask:0xf bank_mask:0xf
    v_mfma_f32_16x16x32_bf16 v[24:27], v[76:79], v[108:111], v[24:27]
    v_and_b32_dpp v68, v13, v4 quad_perm:[1,1,1,1] row_mask:0xf bank_mask:0xf
    v_and_b32_dpp v69, v13, v5 quad_perm:[1,1,1,1] row_mask:0xf bank_mask:0xf
    v_and_b32_dpp v70, v13, v6 quad_perm:[1,1,1,1] row_mask:0xf bank_mask:0xf
    v_and_b32_dpp v71, v13, v7 quad_perm:[1,1,1,1] row_mask:0xf bank_mask:0xf
    v_mfma_f32_16x16x32_bf16 v[48:51], v[64:67], v[96:99], 0
    v_and_b32_dpp v72, v13, v4 quad_perm:[2,2,2,2] row_mask:0xf bank_mask:0xf
    v_and_b32_dpp v73, v13, v5 quad_perm:[2,2,2,2] row_mask:0xf bank_mask:0xf
    v_and_b32_dpp v74, v13, v6 quad_perm:[2,2,2,2] row_mask:0xf bank_mask:0xf
    v_and_b32_dpp v75, v13, v7 quad_perm:[2,2,2,2] row_mask:0xf bank_mask:0xf
    v_mfma_f32_16x16x32_bf16 v[48:51], v[68:71], v[100:103], v[48:51]
    v_and_b32_dpp v76, v13, v4 quad_perm:[3,3,3,3] row_mask:0xf bank_mask:0xf
    v_and_b32_dpp v77, v13, v5 quad_perm:[3,3,3,3] row_mask:0xf bank_mask:0xf
    v_and_b32_dpp v78, v13, v6 quad_perm:[3,3,3,3] row_mask:0xf bank_mask:0xf
    v_and_b32_dpp v79, v13, v7 quad_perm:[3,3,3,3] row_mask:0xf bank_mask:0xf
    v_mfma_f32_16x16x32_bf16 v[48:51], v[72:75], v[104:107], v[48:51]
    s_nop 0
    v_mfma_f32_16x16x32_bf16 v[48:51], v[76:79], v[108:111], v[48:51]
    s_cmp_eq_u32 s56, 0
    s_cbranch_scc1 L_n3b
    v_and_b32_dpp v64, v14, v4 quad_perm:[0,0,0,0] row_mask:0xf bank_mask:0xf
    v_and_b32_dpp v65, v14, v5 quad_perm:[0,0,0,0] row_mask:0xf bank_mask:0xf
    v_and_b32_dpp v66, v14, v6 quad_perm:[0,0,0,0] row_mask:0xf bank_mask:0xf
    v_and_b32_dpp v67, v14, v7 quad_perm:[0,0,0,0] row_mask:0xf bank_mask:0xf
    v_and_b32_dpp v68, v14, v4 quad_perm:[1,1,1,1] row_mask:0xf bank_mask:0xf
    v_and_b32_dpp v69, v14, v5 quad_perm:[1,1,1,1] row_mask:0xf bank_mask:0xf
    v_and_b32_dpp v70, v14, v6 quad_perm:[1,1,1,1] row_mask:0xf bank_mask:0xf
    v_and_b32_dpp v71, v14, v7 quad_perm:[1,1,1,1] row_mask:0xf bank_mask:0xf
    s_waitcnt vmcnt(0)
    v_mfma_f32_16x16x32_bf16 v[24:27], v[64:67], v[112:115], v[24:27]
    v_and_b32_dpp v72, v14, v4 quad_perm:[2,2,2,2] row_mask:0xf bank_mask:0xf
    v_and_b32_dpp v73, v14, v5 quad_perm:[2,2,2,2] row_mask:0xf bank_mask:0xf
    v_and_b32_dpp v74, v14, v6 quad_perm:[2,2,2,2] row_mask:0xf bank_mask:0xf
    v_and_b32_dpp v75, v14, v7 quad_perm:[2,2,2,2] row_mask:0xf bank_mask:0xf
    v_mfma_f32_16x16x32_bf16 v[24:27], v[68:71], v[116:119], v[24:27]
    v_and_b32_dpp v76, v14, v4 quad_perm:[3,3,3,3] row_mask:0xf bank_mask:0xf
    v_and_b32_dpp v77, v14, v5 quad_perm:[3,3,3,3] row_mask:0xf bank_mask:0xf
    v_and_b32_dpp v78, v14, v6 quad_perm:[3,3,3,3] row_mask:0xf bank_mask:0xf
    v_and_b32_dpp v79, v14, v7 quad_perm:[3,3,3,3] row_mask:0xf bank_mask:0xf
    v_mfma_f32_16x16x32_bf16 v[24:27], v[72:75], v[120:123], v[24:27]
    s_nop 0
    v_mfma_f32_16x16x32_bf16 v[24:27], v[76:79], v[124:127], v[24:27]
L_n3b:
    s_setprio 3
L_h4chkb:
    buffer_load_dwordx4 v[32:35], v86, s[20:23], s71 offen sc1
    s_sub_u32 s70, s70, 1
    s_cbranch_scc1 L_h4xb
    s_and_b32 s66, s70, 31
    s_cmp_eq_u32 s66, 1
    s_cselect_b32 s66, 5636096, 0
    s_add_u32 s71, s72, s66
    s_waitcnt vmcnt(0)
    v_cmp_ne_u32 vcc, s53, v35
    v_perm_b32 v35, v34, v33, s63
    v_perm_b32 v35, v35, v32, s64
    s_cbranch_vccnz L_h4chkb
L_h4okb:
    v_permlane32_swap_b32 v32, v34
    v_permlane32_swap_b32 v33, v35
    v_add_f32 v32, v32, v34
    v_add_f32 v33, v33, v35
    s_nop 1
    v_permlane16_swap_b32 v32, v33
    v_add_f32 v32, v32, v33
    v_cvt_pk_bf16_f32 v33, v32, v32
    v_cvt_pk_bf16_f32 v36, v32, v32
    v_cvt_pk_bf16_f32 v32, v32, v32
    s_nop 0
    v_mov_b32_dpp v36, v33 row_ror:8 row_mask:0xf bank_mask:0x3
    v_mov_b32_dpp v32, v33 row_ror:8 row_mask:0xf bank_mask:0xc
    s_nop 1
    v_and_b32_dpp v64, v32, v4 quad_perm:[0,0,0,0] row_mask:0xf bank_mask:0xf
    v_and_b32_dpp v65, v32, v5 quad_perm:[0,0,0,0] row_mask:0xf bank_mask:0xf
    v_and_b32_dpp v66, v32, v6 quad_perm:[0,0,0,0] row_mask:0xf bank_mask:0xf
    v_and_b32_dpp v67, v32, v7 quad_perm:[0,0,0,0] row_mask:0xf bank_mask:0xf
    v_and_b32_dpp v68, v32, v4 quad_perm:[1,1,1,1] row_mask:0xf bank_mask:0xf
    v_and_b32_dpp v69, v32, v5 quad_perm:[1,1,1,1] row_mask:0xf bank_mask:0xf
    v_and_b32_dpp v70, v32, v6 quad_perm:[1,1,1,1] row_mask:0xf bank_mask:0xf
    v_and_b32_dpp v71, v32, v7 quad_perm:[1,1,1,1] row_mask:0xf bank_mask:0xf
    v_mfma_f32_16x16x32_bf16 v[24:27], v[64:67], v[128:131], v[24:27]
    v_and_b32_dpp v72, v32, v4 quad_perm:[2,2,2,2] row_mask:0xf bank_mask:0xf
    v_and_b32_dpp v73, v32, v5 quad_perm:[2,2,2,2] row_mask:0xf bank_mask:0xf
    v_and_b32_dpp v74, v32, v6 quad_perm:[2,2,2,2] row_mask:0xf bank_mask:0xf
    v_and_b32_dpp v75, v32, v7 quad_perm:[2,2,2,2] row_mask:0xf bank_mask:0xf
    v_mfma_f32_16x16x32_bf16 v[24:27], v[68:71], v[132:135], v[24:27]
    v_and_b32_dpp v76, v32, v4 quad_perm:[3,3,3,3] row_mask:0xf bank_mask:0xf
    v_and_b32_dpp v77, v32, v5 quad_perm:[3,3,3,3] row_mask:0xf bank_mask:0xf
    v_and_b32_dpp v78, v32, v6 quad_perm:[3,3,3,3] row_mask:0xf bank_mask:0xf
    v_and_b32_dpp v79, v32, v7 quad_perm:[3,3,3,3] row_mask:0xf bank_mask:0xf
    v_mfma_f32_16x16x32_bf16 v[24:27], v[72:75], v[136:139], v[24:27]
    v_and_b32_dpp v64, v36, v4 quad_perm:[0,0,0,0] row_mask:0xf bank_mask:0xf
    v_and_b32_dpp v65, v36, v5 quad_perm:[0,0,0,0] row_mask:0xf bank_mask:0xf
    v_and_b32_dpp v66, v36, v6 quad_perm:[0,0,0,0] row_mask:0xf bank_mask:0xf
    v_and_b32_dpp v67, v36, v7 quad_perm:[0,0,0,0] row_mask:0xf bank_mask:0xf
    v_mfma_f32_16x16x32_bf16 v[24:27], v[76:79], v[140:143], v[24:27]
    v_and_b32_dpp v68, v36, v4 quad_perm:[1,1,1,1] row_mask:0xf bank_mask:0xf
    v_and_b32_dpp v69, v36, v5 quad_perm:[1,1,1,1] row_mask:0xf bank_mask:0xf
    v_and_b32_dpp v70, v36, v6 quad_perm:[1,1,1,1] row_mask:0xf bank_mask:0xf
    v_and_b32_dpp v71, v36, v7 quad_perm:[1,1,1,1] row_mask:0xf bank_mask:0xf
    v_mfma_f32_16x16x32_bf16 v[48:51], v[64:67], v[128:131], v[48:51]
    v_and_b32_dpp v72, v36, v4 quad_perm:[2,2,2,2] row_mask:0xf bank_mask:0xf
    v_and_b32_dpp v73, v36, v5 quad_perm:[2,2,2,2] row_mask:0xf bank_mask:0xf
    v_and_b32_dpp v74, v36, v6 quad_perm:[2,2,2,2] row_mask:0xf bank_mask:0xf
    v_and_b32_dpp v75, v36, v7 quad_perm:[2,2,2,2] row_mask:0xf bank_mask:0xf
    v_mfma_f32_16x16x32_bf16 v[48:51], v[68:71], v[132:135], v[48:51]
    v_and_b32_dpp v76, v36, v4 quad_perm:[3,3,3,3] row_mask:0xf bank_mask:0xf
    v_and_b32_dpp v77, v36, v5 quad_perm:[3,3,3,3] row_mask:0xf bank_mask:0xf
    v_and_b32_dpp v78, v36, v6 quad_perm:[3,3,3,3] row_mask:0xf bank_mask:0xf
    v_and_b32_dpp v79, v36, v7 quad_perm:[3,3,3,3] row_mask:0xf bank_mask:0xf
    v_mfma_f32_16x16x32_bf16 v[48:51], v[72:75], v[136:139], v[48:51]
    s_nop 0
    v_mfma_f32_16x16x32_bf16 v[48:51], v[76:79], v[140:143], v[48:51]
    s_nop 7
    v_add_f32_dpp v24, v48, v24 row_ror:8 row_mask:0xf bank_mask:0xf
    v_add_f32_dpp v25, v49, v25 row_ror:8 row_mask:0xf bank_mask:0xf
    v_add_f32_dpp v26, v50, v26 row_ror:8 row_mask:0xf bank_mask:0xf
    v_add_f32_dpp v27, v51, v27 row_ror:8 row_mask:0xf bank_mask:0xf
    v_perm_b32 v44, v24, v27, s60
    v_perm_b32 v45, v25, v27, s61
    v_perm_b32 v46, v26, v27, s62
    buffer_store_dwordx4 v[44:47], v91, s[20:23], s75 offen sc1
    s_branch L_fin
L_SC2:
    s_load_dword s53, s[20:21], 0
    s_load_dwordx2 s[28:29], s[0:1], 40
    s_load_dwordx2 s[40:41], s[0:1], 72
    s_mov_b32 s22, 268435456
    s_mov_b32 s23, 0x20000
    s_mov_b32 s30, 4718592
    s_mov_b32 s31, 0x20000
    s_mov_b32 s42, 5308416
    s_mov_b32 s43, 0x20000
    s_lshl_b32 s65, s59, 3
    s_add_u32 s65, s65, s58
    s_and_b32 s52, s3, 3
    s_and_b32 s69, s59, 3
    s_lshl_b32 s54, s58, 2
    s_add_u32 s54, s54, s69
    s_lshr_b32 s55, s59, 2
    v_and_b32 v2, 15, v1
    v_lshrrev_b32 v3, 4, v1
    v_lshlrev_b32 v8, 4, v1
    v_bfe_u32 v9, v1, 2, 1
    v_and_b32 v10, 3, v1
    v_lshlrev_b32 v10, 4, v10
    v_mov_b32 v4, 0xffff
    v_mov_b32 v5, 0
    v_lshlrev_b64 v[4:5], v10, v[4:5]
    v_bfe_i32 v10, v1, 3, 1
    v_and_b32 v6, v10, v4
    v_and_b32 v7, v10, v5
    v_xor_b32 v4, v4, v6
    v_xor_b32 v5, v5, v7
    s_mov_b32 s60, 0x07060501
    s_mov_b32 s61, 0x07060502
    s_mov_b32 s62, 0x07060503
    s_mov_b32 s63, 0x04000c0c
    s_mov_b32 s64, 0x0706000c
    s_mov_b32 s100, 0x01000100
    s_mov_b32 s101, 0x03020302
    s_and_b32 s56, s59, 1
    s_lshr_b32 s67, s57, 5
    s_lshl_b32 s72, s67, 15
    s_lshl_b32 s69, s56, 14
    s_add_u32 s72, s72, s69
    s_lshl_b32 s69, s3, 11
    s_add_u32 s72, s72, s69
    s_add_u32 s72, s72, 327680
    s_mul_i32 s66, s3, 2112
    s_add_u32 s66, s66, 135168
    v_add_u32 v12, s66, v8
    s_mov_b32 s70, 200000
    v_mul_u32_u24 v224, 1056, v2
    v_lshl_add_u32 v224, v3, 4, v224
    v_add_u32 v225, 135168, v224
    s_mul_i32 s66, s52, 33792
    v_add_u32 v224, s66, v224
    v_lshlrev_b32 v226, 2, v2
    v_add_u32 v226, 152064, v226
    v_mov_b32 v10, 0xff800000
    ds_write_b32 v226, v10
    s_lshl_b32 s66, s52, 10
    s_add_u32 s66, s66, 153344
    v_add_u32 v228, s66, v8
    s_lshl_b32 s66, s52, 2
    s_add_u32 s66, s66, 152320
    v_add_u32 v231, s66, v8
    v_lshrrev_b32 v229, 2, v2
    v_lshlrev_b32 v229, 7, v229
    v_and_b32 v10, 3, v2
    v_lshl_add_u32 v229, v10, 4, v229
    s_lshl_b32 s76, s57, 10
    s_lshl_b32 s69, s56, 9
    s_add_u32 s76, s76, s69
    s_add_u32 s76, s76, 393216
    s_mov_b32 s77, 0x3e0293ee
    buffer_load_dwordx4 v8, s[8:11], s71 offen nt lds
    s_add_u32 m0, m0, 1056
    s_xor_b32 s71, s71, 4096
    buffer_load_dwordx4 v8, s[8:11], s71 offen nt lds
    s_add_u32 m0, m0, 1056
    s_xor_b32 s71, s71, 12288
    buffer_load_dwordx4 v8, s[8:11], s71 offen nt lds
    s_add_u32 m0, m0, 1056
    s_xor_b32 s71, s71, 4096
    buffer_load_dwordx4 v8, s[8:11], s71 offen nt lds
    s_add_u32 m0, m0, 1056
    s_xor_b32 s71, s71, 28672
    s_barrier
    buffer_load_dwordx4 v8, s[8:11], s71 offen nt lds
    s_add_u32 m0, m0, 1056
    s_xor_b32 s71, s71, 4096
    buffer_load_dwordx4 v8, s[8:11], s71 offen nt lds
    s_add_u32 m0, m0, 1056
    s_xor_b32 s71, s71, 12288
    buffer_load_dwordx4 v8, s[8:11], s71 offen nt lds
    s_add_u32 m0, m0, 1056
    s_xor_b32 s71, s71, 4096
    buffer_load_dwordx4 v8, s[8:11], s71 offen nt lds
    s_add_u32 m0, m0, 1056
    s_xor_b32 s71, s71, 31744
    buffer_load_dwordx4 v8, s[8:11], s71 offen nt lds
    s_add_u32 m0, m0, 1056
    s_xor_b32 s71, s71, 4096
    buffer_load_dwordx4 v8, s[8:11], s71 offen nt lds
    s_add_u32 m0, m0, 1056
    s_xor_b32 s71, s71, 12288
    buffer_load_dwordx4 v8, s[8:11], s71 offen nt lds
    s_add_u32 m0, m0, 1056
    s_xor_b32 s71, s71, 4096
    buffer_load_dwordx4 v8, s[8:11], s71 offen nt lds
    s_add_u32 m0, m0, 1056
    s_xor_b32 s71, s71, 28672
    buffer_load_dwordx4 v8, s[8:11], s71 offen nt lds
    s_add_u32 m0, m0, 1056
    s_xor_b32 s71, s71, 4096
    buffer_load_dwordx4 v8, s[8:11], s71 offen nt lds
    s_add_u32 m0, m0, 1056
    s_xor_b32 s71, s71, 12288
    buffer_load_dwordx4 v8, s[8:11], s71 offen nt lds
    s_add_u32 m0, m0, 1056
    s_xor_b32 s71, s71, 4096
    buffer_load_dwordx4 v8, s[8:11], s71 offen nt lds
    s_add_u32 m0, m0, 1056
    s_xor_b32 s71, s71, 29696
    buffer_load_dwordx4 v8, s[8:11], s71 offen nt lds
    s_add_u32 m0, m0, 1056
    s_xor_b32 s71, s71, 4096
    buffer_load_dwordx4 v8, s[8:11], s71 offen nt lds
    s_add_u32 m0, m0, 1056
    s_xor_b32 s71, s71, 12288
    buffer_load_dwordx4 v8, s[8:11], s71 offen nt lds
    s_add_u32 m0, m0, 1056
    s_xor_b32 s71, s71, 4096
    buffer_load_dwordx4 v8, s[8:11], s71 offen nt lds
    s_add_u32 m0, m0, 1056
    s_xor_b32 s71, s71, 28672
    buffer_load_dwordx4 v8, s[8:11], s71 offen nt lds
    s_add_u32 m0, m0, 1056
    s_xor_b32 s71, s71, 4096
    buffer_load_dwordx4 v8, s[8:11], s71 offen nt lds
    s_add_u32 m0, m0, 1056
    s_xor_b32 s71, s71, 12288
    buffer_load_dwordx4 v8, s[8:11], s71 offen nt lds
    s_add_u32 m0, m0, 1056
    s_xor_b32 s71, s71, 4096
    buffer_load_dwordx4 v8, s[8:11], s71 offen nt lds
    s_and_b32 s47, s58, 1
    s_lshr_b32 s66, s58, 1
    s_mul_i32 s68, s66, 9
    s_lshl_b32 s69, s47, 2
    s_add_u32 s68, s68, s69
    s_lshl_b32 s36, s68, 7
    s_lshl_b32 s69, s59, 5
    s_add_u32 s36, s36, s69
    s_lshr_b32 s66, s59, 1
    s_and_b32 s67, s59, 1
    s_lshl_b32 s38, s68, 7
    s_lshl_b32 s69, s66, 5
    s_add_u32 s38, s38, s69
    s_lshl_b32 s69, s67, 2
    s_add_u32 s38, s38, s69
    s_add_u32 s38, s38, 1024
    s_cmp_lt_u32 s59, 8
    s_cselect_b32 s69, 1, 0
    s_andn2_b32 s47, s69, s47
    s_mul_i32 s36, s36, 1152
    s_lshl_b32 s69, s52, 8
    s_add_u32 s36, s36, s69
    s_mul_i32 s38, s38, 1152
    s_lshl_b32 s69, s52, 8
    s_add_u32 s38, s38, s69
    s_add_u32 s37, s36, 4608
    s_mul_i32 s39, s54, 147456
    s_mul_i32 s69, s55, 36864
    s_add_u32 s39, s39, s69
    s_lshl_b32 s69, s52, 8
    s_add_u32 s39, s39, s69
    v_mul_u32_u24 v227, 1152, v3
    v_lshl_add_u32 v227, v2, 4, v227
    s_lshl_b32 s74, s58, 10
    s_lshl_b32 s69, s59, 6
    s_add_u32 s74, s74, s69
    s_add_u32 s74, s74, 1015808
    s_waitcnt lgkmcnt(0)
    s_add_u32 s53, s53, 1
    v_and_b32 v11, 3, v1
    v_lshlrev_b32 v11, 3, v11
    s_mul_i32 s66, s53, 0x01010101
    s_xor_b32 s66, s66, 0x6b2d91c4
    v_lshrrev_b32 v11, v11, s66
    v_bfe_u32 v232, v11, 0, 1
    v_bfe_u32 v10, v11, 1, 1
    v_lshl_or_b32 v232, v10, 16, v232
    v_bfe_u32 v233, v11, 2, 1
    v_bfe_u32 v10, v11, 3, 1
    v_lshl_or_b32 v233, v10, 16, v233
    v_bfe_u32 v234, v11, 4, 1
    v_bfe_u32 v10, v11, 5, 1
    v_lshl_or_b32 v234, v10, 16, v234
    v_bfe_u32 v235, v11, 6, 1
    v_bfe_u32 v10, v11, 7, 1
    v_lshl_or_b32 v235, v10, 16, v235
    s_mov_b32 s73, 0x00010001
    s_getreg_b32 s66, hwreg(HW_REG_XCC_ID)
    v_mov_b32 v30, 0
    v_mov_b32 v31, s53
    v_mov_b32 v14, s53
    v_mov_b32 v15, s66
    s_waitcnt vmcnt(16)
    s_barrier
    ds_read_b128 v[96:99], v224 offset:0
    ds_read_b128 v[100:103], v224 offset:64
    ds_read_b128 v[104:107], v224 offset:128
    ds_read_b128 v[108:111], v224 offset:192
    ds_read_b128 v[112:115], v224 offset:256
    ds_read_b128 v[116:119], v224 offset:320
    ds_read_b128 v[120:123], v224 offset:384
    ds_read_b128 v[124:127], v224 offset:448
    ds_read_b128 v[128:131], v224 offset:512
    ds_read_b128 v[132:135], v224 offset:576
    ds_read_b128 v[136:139], v224 offset:640
    ds_read_b128 v[140:143], v224 offset:704
    ds_read_b128 v[144:147], v224 offset:768
    ds_read_b128 v[148:151], v224 offset:832
    ds_read_b128 v[152:155], v224 offset:896
    ds_read_b128 v[156:159], v224 offset:960
    s_waitcnt vmcnt(1)
    s_barrier
    s_waitcnt vmcnt(0)
    ds_read_b128 v[160:163], v224 offset:16896
    ds_read_b128 v[164:167], v224 offset:16960
    ds_read_b128 v[168:171], v224 offset:17024
    ds_read_b128 v[172:175], v224 offset:17088
    ds_read_b128 v[176:179], v224 offset:17152
    ds_read_b128 v[180:183], v224 offset:17216
    ds_read_b128 v[184:187], v224 offset:17280
    ds_read_b128 v[188:191], v224 offset:17344
    ds_read_b128 v[192:195], v224 offset:17408
    ds_read_b128 v[196:199], v224 offset:17472
    ds_read_b128 v[200:203], v224 offset:17536
    ds_read_b128 v[204:207], v224 offset:17600
    ds_read_b128 v[208:211], v224 offset:17664
    ds_read_b128 v[212:215], v224 offset:17728
    ds_read_b128 v[216:219], v224 offset:17792
    ds_read_b128 v[220:223], v224 offset:17856
    s_barrier
    s_setprio 3
    buffer_load_dwordx4 v[16:19], v8, s[20:23], s72 offen sc1
    buffer_load_dwordx4 v[20:23], v8, s[20:23], s72 offen offset:1024 sc1
    s_barrier
    buffer_load_dwordx4 v[236:239], v227, s[40:43], s36 offen nt
    s_add_u32 s36, s36, 9216
    buffer_load_dwordx4 v[240:243], v227, s[40:43], s36 offen nt
    s_add_u32 s36, s36, 9216
L_h2chks:
    s_waitcnt vmcnt(3)
    v_xor_b32 v16, v16, v232
    v_xor_b32 v17, v17, v233
    v_xor_b32 v18, v18, v234
    v_xor_b32 v19, v19, v235
    ds_write_b128 v12, v[16:19]
    v_or3_b32 v13, v16, v17, v18
    s_waitcnt vmcnt(2)
    v_xor_b32 v20, v20, v232
    v_xor_b32 v21, v21, v233
    v_xor_b32 v22, v22, v234
    v_xor_b32 v23, v23, v235
    ds_write_b128 v12, v[20:23] offset:1056
    v_or3_b32 v13, v13, v19, v20
    v_or3_b32 v13, v13, v21, v22
    v_bitop3_b32 v13, v13, v23, s73 bitop3:0xa8
    v_cmp_ne_u32 vcc, 0, v13
    s_cbranch_vccnz L_h2rs
L_h2oks:
    s_waitcnt lgkmcnt(0)
    s_barrier
    ds_read_b128 v[32:35], v225 offset:0
    ds_read_b128 v[36:39], v225 offset:64
    ds_read_b128 v[40:43], v225 offset:128
    ds_read_b128 v[44:47], v225 offset:192
    ds_read_b128 v[48:51], v225 offset:256
    s_waitcnt lgkmcnt(4)
    v_mfma_f32_16x16x32_bf16 v[16:19], v[96:99], v[32:35], 0
    ds_read_b128 v[52:55], v225 offset:320
    v_mfma_f32_16x16x32_bf16 v[20:23], v[160:163], v[32:35], 0
    s_waitcnt lgkmcnt(4)
    v_mfma_f32_16x16x32_bf16 v[16:19], v[100:103], v[36:39], v[16:19]
    ds_read_b128 v[56:59], v225 offset:384
    v_mfma_f32_16x16x32_bf16 v[20:23], v[164:167], v[36:39], v[20:23]
    buffer_load_dwordx4 v[244:247], v227, s[40:43], s36 offen nt
    s_add_u32 s36, s36, 9216
    s_waitcnt lgkmcnt(4)
    v_mfma_f32_16x16x32_bf16 v[16:19], v[104:107], v[40:43], v[16:19]
    ds_read_b128 v[60:63], v225 offset:448
    v_mfma_f32_16x16x32_bf16 v[20:23], v[168:171], v[40:43], v[20:23]
    s_waitcnt lgkmcnt(4)
    v_mfma_f32_16x16x32_bf16 v[16:19], v[108:111], v[44:47], v[16:19]
    ds_read_b128 v[64:67], v225 offset:512
    v_mfma_f32_16x16x32_bf16 v[20:23], v[172:175], v[44:47], v[20:23]
    buffer_load_dwordx4 v[248:251], v227, s[40:43], s36 offen nt
    s_add_u32 s36, s36, 9216
    s_waitcnt lgkmcnt(4)
    v_mfma_f32_16x16x32_bf16 v[16:19], v[112:115], v[48:51], v[16:19]
    ds_read_b128 v[68:71], v225 offset:576
    v_mfma_f32_16x16x32_bf16 v[20:23], v[176:179], v[48:51], v[20:23]
    s_waitcnt lgkmcnt(4)
    v_mfma_f32_16x16x32_bf16 v[16:19], v[116:119], v[52:55], v[16:19]
    ds_read_b128 v[72:75], v225 offset:640
    v_mfma_f32_16x16x32_bf16 v[20:23], v[180:183], v[52:55], v[20:23]
    buffer_load_dwordx4 v[252:255], v227, s[40:43], s37 offen nt
    s_add_u32 s37, s37, 9216
    s_waitcnt lgkmcnt(4)
    v_mfma_f32_16x16x32_bf16 v[16:19], v[120:123], v[56:59], v[16:19]
    ds_read_b128 v[76:79], v225 offset:704
    v_mfma_f32_16x16x32_bf16 v[20:23], v[184:187], v[56:59], v[20:23]
    s_waitcnt lgkmcnt(4)
    v_mfma_f32_16x16x32_bf16 v[16:19], v[124:127], v[60:63], v[16:19]
    ds_read_b128 v[80:83], v225 offset:768
    v_mfma_f32_16x16x32_bf16 v[20:23], v[188:191], v[60:63], v[20:23]
    buffer_load_dwordx4 v[232:235], v227, s[40:43], s37 offen nt
    s_add_u32 s37, s37, 9216
    s_waitcnt lgkmcnt(4)
    v_mfma_f32_16x16x32_bf16 v[16:19], v[128:131], v[64:67], v[16:19]
    ds_read_b128 v[84:87], v225 offset:832
    v_mfma_f32_16x16x32_bf16 v[20:23], v[192:195], v[64:67], v[20:23]
    s_waitcnt lgkmcnt(4)
    v_mfma_f32_16x16x32_bf16 v[16:19], v[132:135], v[68:71], v[16:19]
    ds_read_b128 v[88:91], v225 offset:896
    v_mfma_f32_16x16x32_bf16 v[20:23], v[196:199], v[68:71], v[20:23]
    s_waitcnt lgkmcnt(4)
    v_mfma_f32_16x16x32_bf16 v[16:19], v[136:139], v[72:75], v[16:19]
    ds_read_b128 v[92:95], v225 offset:960
    v_mfma_f32_16x16x32_bf16 v[20:23], v[200:203], v[72:75], v[20:23]
    s_waitcnt lgkmcnt(4)
    v_mfma_f32_16x16x32_bf16 v[16:19], v[140:143], v[76:79], v[16:19]
    v_mfma_f32_16x16x32_bf16 v[20:23], v[204:207], v[76:79], v[20:23]
    s_waitcnt lgkmcnt(3)
    v_mfma_f32_16x16x32_bf16 v[16:19], v[144:147], v[80:83], v[16:19]
    s_waitcnt lgkmcnt(2)
    v_mfma_f32_16x16x32_bf16 v[16:19], v[148:151], v[84:87], v[16:19]
    s_waitcnt lgkmcnt(1)
    v_mfma_f32_16x16x32_bf16 v[16:19], v[152:155], v[88:91], v[16:19]
    s_waitcnt lgkmcnt(0)
    v_mfma_f32_16x16x32_bf16 v[16:19], v[156:159], v[92:95], v[16:19]
    v_mfma_f32_16x16x32_bf16 v[20:23], v[208:211], v[80:83], v[20:23]
    v_mfma_f32_16x16x32_bf16 v[20:23], v[212:215], v[84:87], v[20:23]
    v_mfma_f32_16x16x32_bf16 v[20:23], v[216:219], v[88:91], v[20:23]
    v_mfma_f32_16x16x32_bf16 v[20:23], v[220:223], v[92:95], v[20:23]
    s_nop 3
    v_max3_f32 v28, v16, v17, v18
    v_max_f32 v28, v28, v19
    s_nop 1
    v_max3_f32 v28, v28, v20, v21
    v_max3_f32 v28, v28, v22, v23
    ds_max_f32 v226, v28
    s_waitcnt lgkmcnt(0)
    s_barrier
    ds_read_b32 v28, v226
    s_waitcnt lgkmcnt(0)
    v_mul_f32 v28, s77, v28
    v_fma_f32 v16, v16, s77, -v28
    v_fma_f32 v17, v17, s77, -v28
    v_exp_f32 v16, v16
    v_fma_f32 v18, v18, s77, -v28
    v_exp_f32 v17, v17
    v_fma_f32 v19, v19, s77, -v28
    v_exp_f32 v18, v18
    v_add_f32 v29, v16, v17
    v_cvt_pk_bf16_f32 v24, v16, v17
    v_fma_f32 v20, v20, s77, -v28
    v_exp_f32 v19, v19
    v_add_f32 v29, v29, v18
    v_fma_f32 v21, v21, s77, -v28
    v_exp_f32 v20, v20
    v_add_f32 v29, v29, v19
    v_cvt_pk_bf16_f32 v25, v18, v19
    v_fma_f32 v22, v22, s77, -v28
    v_exp_f32 v21, v21
    v_add_f32 v29, v29, v20
    v_fma_f32 v23, v23, s77, -v28
    v_exp_f32 v22, v22
    v_add_f32 v29, v29, v21
    v_cvt_pk_bf16_f32 v26, v20, v21
    v_exp_f32 v23, v23
    v_add_f32 v29, v29, v22
    v_cvt_pk_bf16_f32 v27, v22, v23
    ds_write_b128 v228, v[24:27]
    v_add_f32 v29, v29, v23
    ds_write_b32 v231, v29
    s_waitcnt lgkmcnt(0)
    s_barrier
    s_setprio 1
    s_cmp_lg_u32 s52, 0
    s_cbranch_scc1 L_nostat
    ds_read_b128 v[24:27], v231
    s_waitcnt lgkmcnt(0)
    v_add_f32 v24, v24, v25
    v_add_f32 v26, v26, v27
    v_add_f32 v29, v24, v26
    v_mov_b32 v24, v29
    s_nop 1
    v_permlane32_swap_b32 v29, v24
    v_add_f32 v29, v29, v24
    v_mov_b32 v24, v29
    s_nop 1
    v_permlane16_swap_b32 v29, v24
    v_add_f32 v29, v29, v24
    s_mov_b64 exec, 0xffff
    buffer_store_dwordx4 v[28:31], v229, s[20:23], s76 offen sc1
    s_mov_b64 exec, -1
L_nostat:
    s_setprio 0
    buffer_load_dwordx4 v[96:99], v227, s[40:43], s37 offen nt
    s_add_u32 s37, s37, 9216
    buffer_load_dwordx4 v[100:103], v227, s[40:43], s37 offen nt
    s_add_u32 s37, s37, 9216
    s_cmp_lg_u32 s52, 0
    s_cbranch_scc1 L_nf3
    s_mov_b64 exec, 1
    buffer_store_dwordx2 v[14:15], v8, s[20:23], s74 offen
    s_mov_b64 exec, -1
L_nf3:
    s_barrier
    s_waitcnt vmcnt(5)
    buffer_load_dwordx4 v[104:107], v227, s[28:31], s39 offen nt
    s_add_u32 s39, s39, 4608
    s_waitcnt vmcnt(5)
    buffer_load_dwordx4 v[108:111], v227, s[28:31], s39 offen nt
    s_add_u32 s39, s39, 4608
    s_waitcnt vmcnt(5)
    buffer_load_dwordx4 v[112:115], v227, s[28:31], s39 offen nt
    s_add_u32 s39, s39, 4608
    s_waitcnt vmcnt(5)
    buffer_load_dwordx4 v[116:119], v227, s[28:31], s39 offen nt
    s_add_u32 s39, s39, 4608
    s_waitcnt vmcnt(5)
    buffer_load_dwordx4 v[120:123], v227, s[28:31], s39 offen nt
    s_add_u32 s39, s39, 4608
    s_waitcnt vmcnt(5)
    buffer_load_dwordx4 v[124:127], v227, s[28:31], s39 offen nt
    s_add_u32 s39, s39, 4608
    s_waitcnt vmcnt(5)
    buffer_load_dwordx4 v[128:131], v227, s[28:31], s39 offen nt
    s_add_u32 s39, s39, 4608
    s_waitcnt vmcnt(5)
    buffer_load_dwordx4 v[132:135], v227, s[28:31], s39 offen nt
    s_add_u32 s39, s39, 4608
    s_cmp_eq_u32 s47, 0
    s_cbranch_scc1 L_no3a
    buffer_load_dwordx4 v[144:147], v227, s[40:43], s38 offen nt
    s_add_u32 s38, s38, 9216
    buffer_load_dwordx4 v[148:151], v227, s[40:43], s38 offen nt
    s_add_u32 s38, s38, 9216
    buffer_load_dwordx4 v[152:155], v227, s[40:43], s38 offen nt
    s_add_u32 s38, s38, 9216
    buffer_load_dwordx4 v[156:159], v227, s[40:43], s38 offen nt
    s_add_u32 s38, s38, 9216
L_no3a:
    v_and_b32 v10, 3, v1
    v_bfe_u32 v11, v1, 3, 1
    v_lshl_add_u32 v10, v11, 2, v10
    v_lshlrev_b32 v86, 10, v3
    v_lshl_add_u32 v86, v9, 9, v86
    v_lshl_add_u32 v86, v10, 4, v86
    s_lshl_b32 s72, s54, 13
    s_lshl_b32 s69, s55, 7
    s_add_u32 s72, s72, s69
    s_add_u32 s72, s72, 65536
    v_mov_b32 v92, 157440
    v_lshlrev_b32 v93, 2, v1
    v_add_u32 v93, 157504, v93
    v_mov_b32 v47, s53
    s_xor_b32 s53, s53, 0x5a5a0000
    s_mov_b32 s71, s72
    s_mov_b32 s70, 200000
    s_mul_i32 s75, s65, 4608
    s_lshl_b32 s69, s52, 10
    s_add_u32 s75, s75, s69
    s_add_u32 s75, s75, 1048576
    s_lshl_b32 s76, s58, 10
    s_lshl_b32 s69, s59, 6
    s_add_u32 s76, s76, s69
    s_add_u32 s76, s76, 983040
    s_cmp_eq_u32 s52, 3
    s_cselect_b32 s76, s76, 1073741824
L_hwa:
    s_sleep 1
    ds_read_b32 v11, v92
    s_waitcnt lgkmcnt(0)
    v_cmp_eq_u32 vcc, 0, v11
    s_cbranch_vccnz L_hwa
    ds_read_b32 v12, v93 offset:0
    ds_read_b32 v13, v93 offset:256
    ds_read_b32 v14, v93 offset:512
    s_waitcnt vmcnt(8) lgkmcnt(0)
    v_and_b32_dpp v64, v12, v4 quad_perm:[0,0,0,0] row_mask:0xf bank_mask:0xf
    v_and_b32_dpp v65, v12, v5 quad_perm:[0,0,0,0] row_mask:0xf bank_mask:0xf
    v_and_b32_dpp v66, v12, v6 quad_perm:[0,0,0,0] row_mask:0xf bank_mask:0xf
    v_and_b32_dpp v67, v12, v7 quad_perm:[0,0,0,0] row_mask:0xf bank_mask:0xf
    v_and_b32_dpp v68, v12, v4 quad_perm:[1,1,1,1] row_mask:0xf bank_mask:0xf
    v_and_b32_dpp v69, v12, v5 quad_perm:[1,1,1,1] row_mask:0xf bank_mask:0xf
    v_and_b32_dpp v70, v12, v6 quad_perm:[1,1,1,1] row_mask:0xf bank_mask:0xf
    v_and_b32_dpp v71, v12, v7 quad_perm:[1,1,1,1] row_mask:0xf bank_mask:0xf
    v_mfma_f32_16x16x32_bf16 v[20:23], v[64:67], v[236:239], 0
    v_and_b32_dpp v72, v12, v4 quad_perm:[2,2,2,2] row_mask:0xf bank_mask:0xf
    v_and_b32_dpp v73, v12, v5 quad_perm:[2,2,2,2] row_mask:0xf bank_mask:0xf
    v_and_b32_dpp v74, v12, v6 quad_perm:[2,2,2,2] row_mask:0xf bank_mask:0xf
    v_and_b32_dpp v75, v12, v7 quad_perm:[2,2,2,2] row_mask:0xf bank_mask:0xf
    v_mfma_f32_16x16x32_bf16 v[20:23], v[68:71], v[240:243], v[20:23]
    v_and_b32_dpp v76, v12, v4 quad_perm:[3,3,3,3] row_mask:0xf bank_mask:0xf
    v_and_b32_dpp v77, v12, v5 quad_perm:[3,3,3,3] row_mask:0xf bank_mask:0xf
    v_and_b32_dpp v78, v12, v6 quad_perm:[3,3,3,3] row_mask:0xf bank_mask:0xf
    v_and_b32_dpp v79, v12, v7 quad_perm:[3,3,3,3] row_mask:0xf bank_mask:0xf
    v_mfma_f32_16x16x32_bf16 v[20:23], v[72:75], v[244:247], v[20:23]
    v_and_b32_dpp v64, v13, v4 quad_perm:[0,0,0,0] row_mask:0xf bank_mask:0xf
    v_and_b32_dpp v65, v13, v5 quad_perm:[0,0,0,0] row_mask:0xf bank_mask:0xf
    v_and_b32_dpp v66, v13, v6 quad_perm:[0,0,0,0] row_mask:0xf bank_mask:0xf
    v_and_b32_dpp v67, v13, v7 quad_perm:[0,0,0,0] row_mask:0xf bank_mask:0xf
    v_mfma_f32_16x16x32_bf16 v[20:23], v[76:79], v[248:251], v[20:23]
    v_and_b32_dpp v68, v13, v4 quad_perm:[1,1,1,1] row_mask:0xf bank_mask:0xf
    v_and_b32_dpp v69, v13, v5 quad_perm:[1,1,1,1] row_mask:0xf bank_mask:0xf
    v_and_b32_dpp v70, v13, v6 quad_perm:[1,1,1,1] row_mask:0xf bank_mask:0xf
    v_and_b32_dpp v71, v13, v7 quad_perm:[1,1,1,1] row_mask:0xf bank_mask:0xf
    v_mfma_f32_16x16x32_bf16 v[20:23], v[64:67], v[252:255], v[20:23]
    v_and_b32_dpp v72, v13, v4 quad_perm:[2,2,2,2] row_mask:0xf bank_mask:0xf
    v_and_b32_dpp v73, v13, v5 quad_perm:[2,2,2,2] row_mask:0xf bank_mask:0xf
    v_and_b32_dpp v74, v13, v6 quad_perm:[2,2,2,2] row_mask:0xf bank_mask:0xf
    v_and_b32_dpp v75, v13, v7 quad_perm:[2,2,2,2] row_mask:0xf bank_mask:0xf
    v_mfma_f32_16x16x32_bf16 v[20:23], v[68:71], v[232:235], v[20:23]
    v_and_b32_dpp v76, v13, v4 quad_perm:[3,3,3,3] row_mask:0xf bank_mask:0xf
    v_and_b32_dpp v77, v13, v5 quad_perm:[3,3,3,3] row_mask:0xf bank_mask:0xf
    v_and_b32_dpp v78, v13, v6 quad_perm:[3,3,3,3] row_mask:0xf bank_mask:0xf
    v_and_b32_dpp v79, v13, v7 quad_perm:[3,3,3,3] row_mask:0xf bank_mask:0xf
    v_mfma_f32_16x16x32_bf16 v[20:23], v[72:75], v[96:99], v[20:23]
    s_nop 0
    v_mfma_f32_16x16x32_bf16 v[20:23], v[76:79], v[100:103], v[20:23]
    s_cmp_eq_u32 s47, 0
    s_cbranch_scc1 L_n3a
    v_and_b32_dpp v64, v14, v4 quad_perm:[0,0,0,0] row_mask:0xf bank_mask:0xf
    v_and_b32_dpp v65, v14, v5 quad_perm:[0,0,0,0] row_mask:0xf bank_mask:0xf
    v_and_b32_dpp v66, v14, v6 quad_perm:[0,0,0,0] row_mask:0xf bank_mask:0xf
    v_and_b32_dpp v67, v14, v7 quad_perm:[0,0,0,0] row_mask:0xf bank_mask:0xf
    v_and_b32_dpp v68, v14, v4 quad_perm:[1,1,1,1] row_mask:0xf bank_mask:0xf
    v_and_b32_dpp v69, v14, v5 quad_perm:[1,1,1,1] row_mask:0xf bank_mask:0xf
    v_and_b32_dpp v70, v14, v6 quad_perm:[1,1,1,1] row_mask:0xf bank_mask:0xf
    v_and_b32_dpp v71, v14, v7 quad_perm:[1,1,1,1] row_mask:0xf bank_mask:0xf
    s_waitcnt vmcnt(0)
    v_mfma_f32_16x16x32_bf16 v[20:23], v[64:67], v[144:147], v[20:23]
    v_and_b32_dpp v72, v14, v4 quad_perm:[2,2,2,2] row_mask:0xf bank_mask:0xf
    v_and_b32_dpp v73, v14, v5 quad_perm:[2,2,2,2] row_mask:0xf bank_mask:0xf
    v_and_b32_dpp v74, v14, v6 quad_perm:[2,2,2,2] row_mask:0xf bank_mask:0xf
    v_and_b32_dpp v75, v14, v7 quad_perm:[2,2,2,2] row_mask:0xf bank_mask:0xf
    v_mfma_f32_16x16x32_bf16 v[20:23], v[68:71], v[148:151], v[20:23]
    v_and_b32_dpp v76, v14, v4 quad_perm:[3,3,3,3] row_mask:0xf bank_mask:0xf
    v_and_b32_dpp v77, v14, v5 quad_perm:[3,3,3,3] row_mask:0xf bank_mask:0xf
    v_and_b32_dpp v78, v14, v6 quad_perm:[3,3,3,3] row_mask:0xf bank_mask:0xf
    v_and_b32_dpp v79, v14, v7 quad_perm:[3,3,3,3] row_mask:0xf bank_mask:0xf
    v_mfma_f32_16x16x32_bf16 v[20:23], v[72:75], v[152:155], v[20:23]
    s_nop 0
    v_mfma_f32_16x16x32_bf16 v[20:23], v[76:79], v[156:159], v[20:23]
L_n3a:
    s_setprio 3
L_h4chka:
    buffer_load_dwordx4 v[32:35], v86, s[20:23], s71 offen sc1
    s_sub_u32 s70, s70, 1
    s_cbranch_scc1 L_h4xa
    s_and_b32 s66, s70, 31
    s_cmp_eq_u32 s66, 1
    s_cselect_b32 s66, 5636096, 0
    s_add_u32 s71, s72, s66
    s_waitcnt vmcnt(0)
    v_cmp_ne_u32 vcc, s53, v35
    v_perm_b32 v35, v34, v33, s63
    v_perm_b32 v35, v35, v32, s64
    s_cbranch_vccnz L_h4chka
L_h4oka:
    v_permlane32_swap_b32 v32, v34
    v_permlane32_swap_b32 v33, v35
    v_add_f32 v32, v32, v34
    v_add_f32 v33, v33, v35
    s_nop 1
    v_permlane16_swap_b32 v32, v33
    v_add_f32 v32, v32, v33
    v_cvt_pk_bf16_f32 v33, v32, v32
    v_cvt_pk_bf16_f32 v36, v32, v32
    v_cvt_pk_bf16_f32 v32, v32, v32
    s_nop 0
    v_mov_b32_dpp v36, v33 row_ror:8 row_mask:0xf bank_mask:0x3
    v_mov_b32_dpp v32, v33 row_ror:8 row_mask:0xf bank_mask:0xc
    s_nop 1
    v_and_b32_dpp v64, v32, v4 quad_perm:[0,0,0,0] row_mask:0xf bank_mask:0xf
    v_and_b32_dpp v65, v32, v5 quad_perm:[0,0,0,0] row_mask:0xf bank_mask:0xf
    v_and_b32_dpp v66, v32, v6 quad_perm:[0,0,0,0] row_mask:0xf bank_mask:0xf
    v_and_b32_dpp v67, v32, v7 quad_perm:[0,0,0,0] row_mask:0xf bank_mask:0xf
    v_and_b32_dpp v68, v32, v4 quad_perm:[1,1,1,1] row_mask:0xf bank_mask:0xf
    v_and_b32_dpp v69, v32, v5 quad_perm:[1,1,1,1] row_mask:0xf bank_mask:0xf
    v_and_b32_dpp v70, v32, v6 quad_perm:[1,1,1,1] row_mask:0xf bank_mask:0xf
    v_and_b32_dpp v71, v32, v7 quad_perm:[1,1,1,1] row_mask:0xf bank_mask:0xf
    v_mfma_f32_16x16x32_bf16 v[20:23], v[64:67], v[104:107], v[20:23]
    v_and_b32_dpp v72, v32, v4 quad_perm:[2,2,2,2] row_mask:0xf bank_mask:0xf
    v_and_b32_dpp v73, v32, v5 quad_perm:[2,2,2,2] row_mask:0xf bank_mask:0xf
    v_and_b32_dpp v74, v32, v6 quad_perm:[2,2,2,2] row_mask:0xf bank_mask:0xf
    v_and_b32_dpp v75, v32, v7 quad_perm:[2,2,2,2] row_mask:0xf bank_mask:0xf
    v_mfma_f32_16x16x32_bf16 v[20:23], v[68:71], v[108:111], v[20:23]
    v_and_b32_dpp v76, v32, v4 quad_perm:[3,3,3,3] row_mask:0xf bank_mask:0xf
    v_and_b32_dpp v77, v32, v5 quad_perm:[3,3,3,3] row_mask:0xf bank_mask:0xf
    v_and_b32_dpp v78, v32, v6 quad_perm:[3,3,3,3] row_mask:0xf bank_mask:0xf
    v_and_b32_dpp v79, v32, v7 quad_perm:[3,3,3,3] row_mask:0xf bank_mask:0xf
    v_mfma_f32_16x16x32_bf16 v[20:23], v[72:75], v[112:115], v[20:23]
    v_and_b32_dpp v64, v36, v4 quad_perm:[0,0,0,0] row_mask:0xf bank_mask:0xf
    v_and_b32_dpp v65, v36, v5 quad_perm:[0,0,0,0] row_mask:0xf bank_mask:0xf
    v_and_b32_dpp v66, v36, v6 quad_perm:[0,0,0,0] row_mask:0xf bank_mask:0xf
    v_and_b32_dpp v67, v36, v7 quad_perm:[0,0,0,0] row_mask:0xf bank_mask:0xf
    v_mfma_f32_16x16x32_bf16 v[20:23], v[76:79], v[116:119], v[20:23]
    v_and_b32_dpp v68, v36, v4 quad_perm:[1,1,1,1] row_mask:0xf bank_mask:0xf
    v_and_b32_dpp v69, v36, v5 quad_perm:[1,1,1,1] row_mask:0xf bank_mask:0xf
    v_and_b32_dpp v70, v36, v6 quad_perm:[1,1,1,1] row_mask:0xf bank_mask:0xf
    v_and_b32_dpp v71, v36, v7 quad_perm:[1,1,1,1] row_mask:0xf bank_mask:0xf
    v_mfma_f32_16x16x32_bf16 v[20:23], v[64:67], v[120:123], v[20:23]
    v_and_b32_dpp v72, v36, v4 quad_perm:[2,2,2,2] row_mask:0xf bank_mask:0xf
    v_and_b32_dpp v73, v36, v5 quad_perm:[2,2,2,2] row_mask:0xf bank_mask:0xf
    v_and_b32_dpp v74, v36, v6 quad_perm:[2,2,2,2] row_mask:0xf bank_mask:0xf
    v_and_b32_dpp v75, v36, v7 quad_perm:[2,2,2,2] row_mask:0xf bank_mask:0xf
    v_mfma_f32_16x16x32_bf16 v[20:23], v[68:71], v[124:127], v[20:23]
    v_and_b32_dpp v76, v36, v4 quad_perm:[3,3,3,3] row_mask:0xf bank_mask:0xf
    v_and_b32_dpp v77, v36, v5 quad_perm:[3,3,3,3] row_mask:0xf bank_mask:0xf
    v_and_b32_dpp v78, v36, v6 quad_perm:[3,3,3,3] row_mask:0xf bank_mask:0xf
    v_and_b32_dpp v79, v36, v7 quad_perm:[3,3,3,3] row_mask:0xf bank_mask:0xf
    v_mfma_f32_16x16x32_bf16 v[20:23], v[72:75], v[128:131], v[20:23]
    s_nop 0
    v_mfma_f32_16x16x32_bf16 v[20:23], v[76:79], v[132:135], v[20:23]
    s_nop 7
    v_perm_b32 v44, v20, v23, s60
    v_perm_b32 v45, v21, v23, s61
    v_perm_b32 v46, v22, v23, s62
    buffer_store_dwordx4 v[44:47], v8, s[20:23], s75 offen sc1
    s_mov_b64 exec, 1
    buffer_store_dword v47, v8, s[20:23], s76 offen
    s_mov_b64 exec, -1
L_fin:
L_end:
    s_endpgm
L_g3_r:
    s_waitcnt vmcnt(0)
    s_branch L_g3_k
L_str:
    s_sub_u32 s70, s70, 1
    s_cbranch_scc1 L_stok
    s_mov_b64 exec, vcc
    buffer_load_dwordx4 v[32:35], v87, s[20:23], s77 offen sc1
    s_branch L_stw
L_h3r:
    s_sub_u32 s70, s70, 1
    s_cbranch_scc1 L_h3ok
    buffer_load_dwordx4 v[48:51], v91, s[20:23], s72 offen sc1
    buffer_load_dwordx4 v[52:55], v92, s[20:23], s72 offen sc1
    buffer_load_dwordx4 v[56:59], v93, s[20:23], s72 offen sc1
    buffer_load_dwordx4 v[60:63], v94, s[20:23], s72 offen sc1
    s_waitcnt vmcnt(0)
    s_branch L_h3chk
L_g5_r:
    s_waitcnt vmcnt(0)
    s_branch L_g5_k
L_h5r:
    s_waitcnt vmcnt(0)
    s_branch L_h5ok
L_af_r:
    s_waitcnt vmcnt(0)
    s_branch L_af_k
L_h2rp:
    s_sub_u32 s70, s70, 1
    s_cbranch_scc1 L_h2okp
    s_waitcnt lgkmcnt(0)
    buffer_load_dwordx4 v[16:19], v8, s[20:23], s72 offen sc1
    buffer_load_dwordx4 v[20:23], v8, s[20:23], s72 offen offset:1024 sc1
    s_waitcnt vmcnt(0)
    s_branch L_h2chkp
L_h4xb:
    s_waitcnt vmcnt(0)
    s_branch L_h4okb
L_h2rs:
    s_sub_u32 s70, s70, 1
    s_cbranch_scc1 L_h2oks
    s_waitcnt lgkmcnt(0)
    buffer_load_dwordx4 v[16:19], v8, s[20:23], s72 offen sc1
    buffer_load_dwordx4 v[20:23], v8, s[20:23], s72 offen offset:1024 sc1
    s_waitcnt vmcnt(0)
    s_branch L_h2chks
L_h4xa:
    s_waitcnt vmcnt(0)
    s_branch L_h4oka
L_code1:
.section .rodata,"a"
.p2align 6
.amdhsa_kernel parallel_sum__compressed_kv_cla__dense_activation_squared_relu__decode_kernel
  .amdhsa_next_free_vgpr 256
  .amdhsa_next_free_sgpr 102
  .amdhsa_accum_offset 256
  .amdhsa_group_segment_fixed_size 0
  .amdhsa_kernarg_size 112
  .amdhsa_user_sgpr_count 2
  .amdhsa_user_sgpr_kernarg_segment_ptr 1
  .amdhsa_system_sgpr_workgroup_id_x 1
  .amdhsa_float_denorm_mode_32 3
.end_amdhsa_kernel
```
